```python
import torch

def _softmax(x, axis=-1):
    return torch.softmax(x, dim=axis)
def _gelu(x):
    return torch.nn.functional.gelu(x, approximate="tanh")
def _silu(x):
    return torch.nn.functional.silu(x)
def _sigmoid(x):
    return torch.sigmoid(x)
def _layernorm(x, axis=-1, eps=1e-5):
    m = x.mean(dim=axis, keepdim=True)
    v = x.var(dim=axis, keepdim=True, unbiased=False)
    return (x - m) / torch.sqrt(v + eps)
def _scatter_add(tgt, idx, src, axis=0):
    return tgt.clone().index_add_(axis, idx, src)
def _segment_sum(src, seg, n):
    out = torch.zeros((n,) + src.shape[1:], dtype=src.dtype)
    return out.index_add_(0, seg, src)
def _pad(x, pw):
    flat = tuple(v for pair in reversed(pw) for v in pair)
    return torch.nn.functional.pad(x, flat)

kernel_name = 'concat_heads__ssm_conv_h3__spectral_fnet__prompt'

def setup_inputs():

    _w = (lambda a: (lambda t: t.to(torch.bfloat16) if t.is_floating_point() else t)(torch.as_tensor(a)))
    def _A_setup():
        B, S, D = 1, 2048, 640
        ks = 4
        return {
            "q": _w((lambda *s: torch.randn(*s, dtype=torch.bfloat16) * 0.05)(B, S, D)),
            "k": _w((lambda *s: torch.randn(*s, dtype=torch.bfloat16) * 3.2)(B, S, D)),
            "v": _w((lambda *s: torch.randn(*s, dtype=torch.bfloat16) * 3.2)(B, S, D)),
            "shift_k": _w((lambda *s: torch.randn(*s, dtype=torch.bfloat16) * 3.2)(D, ks) * 0.5),
            "ssm_k": _w((lambda *s: torch.randn(*s, dtype=torch.bfloat16) * 3.2)(D, S) * (1.0 / S ** 0.5)),
            "ssm_D": _w((lambda *s: torch.randn(*s, dtype=torch.bfloat16) * 3.2)(D)),
        }
    _A_in = _A_setup()

    def _B_setup():
        B, S, D = 1, 2048, 640
        ns = torch.arange(S)[:, None] * torch.arange(S)[None, :]
        nd = torch.arange(D)[:, None] * torch.arange(D)[None, :]
        Ws_re = torch.cos(-2.0 * torch.pi * ns / S).to(float)
        Ws_im = torch.sin(-2.0 * torch.pi * ns / S).to(float)
        Wd_re = torch.cos(-2.0 * torch.pi * nd / D).to(float)
        Wd_im = torch.sin(-2.0 * torch.pi * nd / D).to(float)
        return {
            "x": _w((lambda *s: torch.randn(*s, dtype=torch.bfloat16) * 0.05)(B, S, D)),
            "dft_seq_re": _w(Ws_re),
            "dft_seq_im": _w(Ws_im),
            "dft_hid_re": _w(Wd_re),
            "dft_hid_im": _w(Wd_im),
        }
    _B_in = _B_setup()

    return {
        "A_q": _A_in["q"],
        "A_k": _A_in["k"],
        "A_v": _A_in["v"],
        "A_shift_k": _A_in["shift_k"],
        "A_ssm_k": _A_in["ssm_k"],
        "A_ssm_D": _A_in["ssm_D"],
        "B_x": _B_in["x"],
        "B_dft_seq_re": _B_in["dft_seq_re"],
        "B_dft_seq_im": _B_in["dft_seq_im"],
        "B_dft_hid_re": _B_in["dft_hid_re"],
        "B_dft_hid_im": _B_in["dft_hid_im"],
    }

def reference(A_q, A_k, A_v, A_shift_k, A_ssm_k, A_ssm_D, B_x, B_dft_seq_re, B_dft_seq_im, B_dft_hid_re, B_dft_hid_im):
    def _A_ref(q, k, v, shift_k, ssm_k, ssm_D):
        B, S, D = q.shape
        ks = shift_k.shape[-1]
        k_pad = _pad(k, ((0, 0), (ks - 1, 0), (0, 0)))
        k_shift = torch.zeros_like(k)
        for t in range(ks):
            k_shift = k_shift + k_pad[:, t:t + S, :] * shift_k[:, ks - 1 - t][None, None, :]
        kv = k_shift * v
        L = 2 * S
        kv_pad = _pad(kv, ((0, 0), (0, S), (0, 0)))
        kf_pad = _pad(ssm_k, ((0, 0), (0, S)))
        kv_f = (lambda x, axes=(-2,-1): torch.fft.rfft2(x.float(), dim=axes))(kv_pad[:, None, :, :], axes=(1, 2))
        kf_f = (lambda x, axes=(-2,-1): torch.fft.rfft2(x.float(), dim=axes))(kf_pad[:, None, :], axes=(1, 2))
        kf_f = (lambda x, *d: x.permute(*d))(kf_f, 1, 2, 0)
        y_f = kv_f * kf_f[None, :, :, :]
        y = (lambda x, s, axes=(-2,-1): torch.fft.irfft2(x, s=s, dim=axes).to(torch.bfloat16))(y_f, (1, L), axes=(1, 2))[:, 0, :S, :]
        y = y + kv * ssm_D[None, None, :]
        return q * y

    def _B_ref(x, dft_seq_re, dft_seq_im, dft_hid_re, dft_hid_im):
        a = torch.einsum("bsd,ed->bse", x, dft_hid_re)
        b = torch.einsum("bsd,ed->bse", x, dft_hid_im)
        y = torch.einsum("ts,bse->bte", dft_seq_re, a) - torch.einsum("ts,bse->bte", dft_seq_im, b)
        return y

    a = _A_ref(A_q, A_k, A_v, A_shift_k, A_ssm_k, A_ssm_D)
    b = _B_ref(B_x, B_dft_seq_re, B_dft_seq_im, B_dft_hid_re, B_dft_hid_im)
    return torch.concatenate([a, b], axis=-1)
```

```asm
; @launch kernel=g1_kernel grid=(256,1,1) block=(256,1,1) lds=159744
; @launch kernel=pa_kernel grid=(160,1,1) block=(256,1,1) lds=158720
; @launch kernel=g2_kernel grid=(256,1,1) block=(256,1,1) lds=159744
; @launch kernel=cb_kernel grid=(640,1,1) block=(256,1,1) lds=0
.amdgcn_target "amdgcn-amd-amdhsa--gfx950"
.text
.p2align 8
g1_kernel:
s_cmp_ge_u32 s2, 256
s_cbranch_scc1 g1_kernel_done
s_load_dwordx2 s[4:5], s[0:1], 48
s_load_dwordx4 s[24:27], s[0:1], 72
s_load_dwordx2 s[28:29], s[0:1], 104
s_waitcnt lgkmcnt(0)
s_and_b32 s30, s2, 15
s_lshr_b32 s31, s2, 4
s_mul_i32 s32, s30, 128*1280
s_add_u32 s4, s4, s32
s_addc_u32 s5, s5, 0
s_cmp_ge_u32 s31, 8
s_cselect_b32 s6, s26, s24
s_cselect_b32 s7, s27, s25
s_and_b32 s33, s31, 7
s_mul_i32 s32, s33, 80*1280
s_add_u32 s6, s6, s32
s_addc_u32 s7, s7, 0
s_mul_i32 s32, s31, 80*4096
s_lshl_b32 s33, s30, 8
s_add_u32 s32, s32, s33
s_add_u32 s28, s28, s32
s_addc_u32 s29, s29, 0
s_mov_b32 s8, s4
s_and_b32 s9, s5, 0xffff
s_mov_b32 s10, 0x7fffffff
s_mov_b32 s11, 0x20000
s_mov_b32 s12, s6
s_and_b32 s13, s7, 0xffff
s_mov_b32 s14, 0x7fffffff
s_mov_b32 s15, 0x20000
s_mov_b32 s16, s28
s_and_b32 s17, s29, 0xffff
s_mov_b32 s18, 0x7fffffff
s_mov_b32 s19, 0x20000
v_and_b32 v1, 63, v0
v_lshrrev_b32 v15, 6, v0
s_nop 0
v_readfirstlane_b32 s35, v15
s_lshl_b32 s36, s35, 13
s_mul_i32 s37, s35, 5120
s_add_u32 s37, s37, 32768
v_lshrrev_b32 v16, 4, v1
v_and_b32 v17, 15, v1
s_lshl_b32 s38, s35, 5
s_add_u32 s38, s38, 0
v_add_u32 v18, s38, v16
v_and_b32 v19, 15, v18
v_xor_b32 v19, v19, v17
v_lshlrev_b32 v19, 4, v19
s_mov_b32 s39, 1280
v_mul_lo_u32 v18, v18, s39
v_add_u32 v2, v18, v19
s_lshl_b32 s38, s35, 5
s_add_u32 s38, s38, 4
v_add_u32 v18, s38, v16
v_and_b32 v19, 15, v18
v_xor_b32 v19, v19, v17
v_lshlrev_b32 v19, 4, v19
s_mov_b32 s39, 1280
v_mul_lo_u32 v18, v18, s39
v_add_u32 v3, v18, v19
s_lshl_b32 s38, s35, 5
s_add_u32 s38, s38, 8
v_add_u32 v18, s38, v16
v_and_b32 v19, 15, v18
v_xor_b32 v19, v19, v17
v_lshlrev_b32 v19, 4, v19
s_mov_b32 s39, 1280
v_mul_lo_u32 v18, v18, s39
v_add_u32 v4, v18, v19
s_lshl_b32 s38, s35, 5
s_add_u32 s38, s38, 12
v_add_u32 v18, s38, v16
v_and_b32 v19, 15, v18
v_xor_b32 v19, v19, v17
v_lshlrev_b32 v19, 4, v19
s_mov_b32 s39, 1280
v_mul_lo_u32 v18, v18, s39
v_add_u32 v5, v18, v19
s_lshl_b32 s38, s35, 5
s_add_u32 s38, s38, 16
v_add_u32 v18, s38, v16
v_and_b32 v19, 15, v18
v_xor_b32 v19, v19, v17
v_lshlrev_b32 v19, 4, v19
s_mov_b32 s39, 1280
v_mul_lo_u32 v18, v18, s39
v_add_u32 v6, v18, v19
s_lshl_b32 s38, s35, 5
s_add_u32 s38, s38, 20
v_add_u32 v18, s38, v16
v_and_b32 v19, 15, v18
v_xor_b32 v19, v19, v17
v_lshlrev_b32 v19, 4, v19
s_mov_b32 s39, 1280
v_mul_lo_u32 v18, v18, s39
v_add_u32 v7, v18, v19
s_lshl_b32 s38, s35, 5
s_add_u32 s38, s38, 24
v_add_u32 v18, s38, v16
v_and_b32 v19, 15, v18
v_xor_b32 v19, v19, v17
v_lshlrev_b32 v19, 4, v19
s_mov_b32 s39, 1280
v_mul_lo_u32 v18, v18, s39
v_add_u32 v8, v18, v19
s_lshl_b32 s38, s35, 5
s_add_u32 s38, s38, 28
v_add_u32 v18, s38, v16
v_and_b32 v19, 15, v18
v_xor_b32 v19, v19, v17
v_lshlrev_b32 v19, 4, v19
s_mov_b32 s39, 1280
v_mul_lo_u32 v18, v18, s39
v_add_u32 v9, v18, v19
s_mul_i32 s38, s35, 20
s_add_u32 s38, s38, 0
v_add_u32 v18, s38, v16
v_and_b32 v19, 15, v18
v_xor_b32 v19, v19, v17
v_lshlrev_b32 v19, 4, v19
s_mov_b32 s39, 1280
v_mul_lo_u32 v18, v18, s39
v_add_u32 v10, v18, v19
s_mul_i32 s38, s35, 20
s_add_u32 s38, s38, 4
v_add_u32 v18, s38, v16
v_and_b32 v19, 15, v18
v_xor_b32 v19, v19, v17
v_lshlrev_b32 v19, 4, v19
s_mov_b32 s39, 1280
v_mul_lo_u32 v18, v18, s39
v_add_u32 v11, v18, v19
s_mul_i32 s38, s35, 20
s_add_u32 s38, s38, 8
v_add_u32 v18, s38, v16
v_and_b32 v19, 15, v18
v_xor_b32 v19, v19, v17
v_lshlrev_b32 v19, 4, v19
s_mov_b32 s39, 1280
v_mul_lo_u32 v18, v18, s39
v_add_u32 v12, v18, v19
s_mul_i32 s38, s35, 20
s_add_u32 s38, s38, 12
v_add_u32 v18, s38, v16
v_and_b32 v19, 15, v18
v_xor_b32 v19, v19, v17
v_lshlrev_b32 v19, 4, v19
s_mov_b32 s39, 1280
v_mul_lo_u32 v18, v18, s39
v_add_u32 v13, v18, v19
s_mul_i32 s38, s35, 20
s_add_u32 s38, s38, 16
v_add_u32 v18, s38, v16
v_and_b32 v19, 15, v18
v_xor_b32 v19, v19, v17
v_lshlrev_b32 v19, 4, v19
s_mov_b32 s39, 1280
v_mul_lo_u32 v18, v18, s39
v_add_u32 v14, v18, v19
v_lshrrev_b32 v18, 2, v17
v_and_b32 v19, 3, v17
v_xor_b32 v19, v19, v16
v_lshlrev_b32 v28, 8, v17
s_lshl_b32 s38, s35, 13
v_add_u32 v29, s38, v28
v_xor_b32 v30, 0, v18
v_lshlrev_b32 v30, 2, v30
v_or_b32 v30, v30, v19
v_lshlrev_b32 v30, 4, v30
v_add_u32 v20, v29, v30
v_add_u32 v24, v28, v30
v_add_u32 v24, 32768, v24
v_xor_b32 v30, 1, v18
v_lshlrev_b32 v30, 2, v30
v_or_b32 v30, v30, v19
v_lshlrev_b32 v30, 4, v30
v_add_u32 v21, v29, v30
v_add_u32 v25, v28, v30
v_add_u32 v25, 32768, v25
v_xor_b32 v30, 2, v18
v_lshlrev_b32 v30, 2, v30
v_or_b32 v30, v30, v19
v_lshlrev_b32 v30, 4, v30
v_add_u32 v22, v29, v30
v_add_u32 v26, v28, v30
v_add_u32 v26, 32768, v26
v_xor_b32 v30, 3, v18
v_lshlrev_b32 v30, 2, v30
v_or_b32 v30, v30, v19
v_lshlrev_b32 v30, 4, v30
v_add_u32 v23, v29, v30
v_add_u32 v27, v28, v30
v_add_u32 v27, 32768, v27
v_mov_b32 v96, 0
v_mov_b32 v97, 0
v_mov_b32 v98, 0
v_mov_b32 v99, 0
v_mov_b32 v100, 0
v_mov_b32 v101, 0
v_mov_b32 v102, 0
v_mov_b32 v103, 0
v_mov_b32 v104, 0
v_mov_b32 v105, 0
v_mov_b32 v106, 0
v_mov_b32 v107, 0
v_mov_b32 v108, 0
v_mov_b32 v109, 0
v_mov_b32 v110, 0
v_mov_b32 v111, 0
v_mov_b32 v112, 0
v_mov_b32 v113, 0
v_mov_b32 v114, 0
v_mov_b32 v115, 0
v_mov_b32 v116, 0
v_mov_b32 v117, 0
v_mov_b32 v118, 0
v_mov_b32 v119, 0
v_mov_b32 v120, 0
v_mov_b32 v121, 0
v_mov_b32 v122, 0
v_mov_b32 v123, 0
v_mov_b32 v124, 0
v_mov_b32 v125, 0
v_mov_b32 v126, 0
v_mov_b32 v127, 0
v_mov_b32 v128, 0
v_mov_b32 v129, 0
v_mov_b32 v130, 0
v_mov_b32 v131, 0
v_mov_b32 v132, 0
v_mov_b32 v133, 0
v_mov_b32 v134, 0
v_mov_b32 v135, 0
s_mov_b32 s40, 0
s_add_u32 m0, s36, 0
s_nop 0
buffer_load_dwordx4 v2, s[8:11], s40 offen lds
s_add_u32 m0, s36, 1024
s_nop 0
buffer_load_dwordx4 v3, s[8:11], s40 offen lds
s_add_u32 m0, s36, 2048
s_nop 0
buffer_load_dwordx4 v4, s[8:11], s40 offen lds
s_add_u32 m0, s36, 3072
s_nop 0
buffer_load_dwordx4 v5, s[8:11], s40 offen lds
s_add_u32 m0, s36, 4096
s_nop 0
buffer_load_dwordx4 v6, s[8:11], s40 offen lds
s_add_u32 m0, s36, 5120
s_nop 0
buffer_load_dwordx4 v7, s[8:11], s40 offen lds
s_add_u32 m0, s36, 6144
s_nop 0
buffer_load_dwordx4 v8, s[8:11], s40 offen lds
s_add_u32 m0, s36, 7168
s_nop 0
buffer_load_dwordx4 v9, s[8:11], s40 offen lds
s_add_u32 m0, s37, 0
s_nop 0
buffer_load_dwordx4 v10, s[12:15], s40 offen lds
s_add_u32 m0, s37, 1024
s_nop 0
buffer_load_dwordx4 v11, s[12:15], s40 offen lds
s_add_u32 m0, s37, 2048
s_nop 0
buffer_load_dwordx4 v12, s[12:15], s40 offen lds
s_add_u32 m0, s37, 3072
s_nop 0
buffer_load_dwordx4 v13, s[12:15], s40 offen lds
s_add_u32 m0, s37, 4096
s_nop 0
buffer_load_dwordx4 v14, s[12:15], s40 offen lds
s_mov_b32 s40, 256
s_add_u32 m0, s36, 53248
s_nop 0
buffer_load_dwordx4 v2, s[8:11], s40 offen lds
s_add_u32 m0, s36, 54272
s_nop 0
buffer_load_dwordx4 v3, s[8:11], s40 offen lds
s_add_u32 m0, s36, 55296
s_nop 0
buffer_load_dwordx4 v4, s[8:11], s40 offen lds
s_add_u32 m0, s36, 56320
s_nop 0
buffer_load_dwordx4 v5, s[8:11], s40 offen lds
s_add_u32 m0, s36, 57344
s_nop 0
buffer_load_dwordx4 v6, s[8:11], s40 offen lds
s_add_u32 m0, s36, 58368
s_nop 0
buffer_load_dwordx4 v7, s[8:11], s40 offen lds
s_add_u32 m0, s36, 59392
s_nop 0
buffer_load_dwordx4 v8, s[8:11], s40 offen lds
s_add_u32 m0, s36, 60416
s_nop 0
buffer_load_dwordx4 v9, s[8:11], s40 offen lds
s_add_u32 m0, s37, 53248
s_nop 0
buffer_load_dwordx4 v10, s[12:15], s40 offen lds
s_add_u32 m0, s37, 54272
s_nop 0
buffer_load_dwordx4 v11, s[12:15], s40 offen lds
s_add_u32 m0, s37, 55296
s_nop 0
buffer_load_dwordx4 v12, s[12:15], s40 offen lds
s_add_u32 m0, s37, 56320
s_nop 0
buffer_load_dwordx4 v13, s[12:15], s40 offen lds
s_add_u32 m0, s37, 57344
s_nop 0
buffer_load_dwordx4 v14, s[12:15], s40 offen lds
s_waitcnt vmcnt(13)
s_barrier
v_add_u32 v88, 0, v20
v_add_u32 v92, 0, v24
v_add_u32 v89, 0, v21
v_add_u32 v93, 0, v25
v_add_u32 v90, 0, v22
v_add_u32 v94, 0, v26
v_add_u32 v91, 0, v23
v_add_u32 v95, 0, v27
s_mov_b32 s40, 512
ds_read_b128 v[32:35], v88 offset:0
ds_read_b128 v[36:39], v88 offset:4096
ds_read_b128 v[40:43], v92 offset:0
ds_read_b128 v[44:47], v92 offset:4096
ds_read_b128 v[48:51], v92 offset:8192
ds_read_b128 v[52:55], v92 offset:12288
ds_read_b128 v[56:59], v92 offset:16384
ds_read_b128 v[60:63], v89 offset:0
ds_read_b128 v[64:67], v89 offset:4096
ds_read_b128 v[68:71], v93 offset:0
ds_read_b128 v[72:75], v93 offset:4096
ds_read_b128 v[76:79], v93 offset:8192
ds_read_b128 v[80:83], v93 offset:12288
ds_read_b128 v[84:87], v93 offset:16384
s_waitcnt lgkmcnt(7)
v_mfma_f32_16x16x32_bf16 v[96:99], v[32:35], v[40:43], v[96:99]
v_mfma_f32_16x16x32_bf16 v[100:103], v[32:35], v[44:47], v[100:103]
v_mfma_f32_16x16x32_bf16 v[104:107], v[32:35], v[48:51], v[104:107]
v_mfma_f32_16x16x32_bf16 v[108:111], v[32:35], v[52:55], v[108:111]
v_mfma_f32_16x16x32_bf16 v[112:115], v[32:35], v[56:59], v[112:115]
v_mfma_f32_16x16x32_bf16 v[116:119], v[36:39], v[40:43], v[116:119]
v_mfma_f32_16x16x32_bf16 v[120:123], v[36:39], v[44:47], v[120:123]
v_mfma_f32_16x16x32_bf16 v[124:127], v[36:39], v[48:51], v[124:127]
v_mfma_f32_16x16x32_bf16 v[128:131], v[36:39], v[52:55], v[128:131]
v_mfma_f32_16x16x32_bf16 v[132:135], v[36:39], v[56:59], v[132:135]
s_add_u32 m0, s36, 106496
s_nop 0
buffer_load_dwordx4 v2, s[8:11], s40 offen lds
s_add_u32 m0, s36, 107520
s_nop 0
buffer_load_dwordx4 v3, s[8:11], s40 offen lds
s_add_u32 m0, s36, 108544
s_nop 0
buffer_load_dwordx4 v4, s[8:11], s40 offen lds
s_add_u32 m0, s36, 109568
s_nop 0
buffer_load_dwordx4 v5, s[8:11], s40 offen lds
ds_read_b128 v[32:35], v90 offset:0
ds_read_b128 v[36:39], v90 offset:4096
ds_read_b128 v[40:43], v94 offset:0
ds_read_b128 v[44:47], v94 offset:4096
ds_read_b128 v[48:51], v94 offset:8192
ds_read_b128 v[52:55], v94 offset:12288
ds_read_b128 v[56:59], v94 offset:16384
s_waitcnt lgkmcnt(7)
v_mfma_f32_16x16x32_bf16 v[96:99], v[60:63], v[68:71], v[96:99]
v_mfma_f32_16x16x32_bf16 v[100:103], v[60:63], v[72:75], v[100:103]
v_mfma_f32_16x16x32_bf16 v[104:107], v[60:63], v[76:79], v[104:107]
v_mfma_f32_16x16x32_bf16 v[108:111], v[60:63], v[80:83], v[108:111]
v_mfma_f32_16x16x32_bf16 v[112:115], v[60:63], v[84:87], v[112:115]
v_mfma_f32_16x16x32_bf16 v[116:119], v[64:67], v[68:71], v[116:119]
v_mfma_f32_16x16x32_bf16 v[120:123], v[64:67], v[72:75], v[120:123]
v_mfma_f32_16x16x32_bf16 v[124:127], v[64:67], v[76:79], v[124:127]
v_mfma_f32_16x16x32_bf16 v[128:131], v[64:67], v[80:83], v[128:131]
v_mfma_f32_16x16x32_bf16 v[132:135], v[64:67], v[84:87], v[132:135]
s_add_u32 m0, s36, 110592
s_nop 0
buffer_load_dwordx4 v6, s[8:11], s40 offen lds
s_add_u32 m0, s36, 111616
s_nop 0
buffer_load_dwordx4 v7, s[8:11], s40 offen lds
s_add_u32 m0, s36, 112640
s_nop 0
buffer_load_dwordx4 v8, s[8:11], s40 offen lds
ds_read_b128 v[60:63], v91 offset:0
ds_read_b128 v[64:67], v91 offset:4096
ds_read_b128 v[68:71], v95 offset:0
ds_read_b128 v[72:75], v95 offset:4096
ds_read_b128 v[76:79], v95 offset:8192
ds_read_b128 v[80:83], v95 offset:12288
ds_read_b128 v[84:87], v95 offset:16384
s_waitcnt lgkmcnt(7)
v_mfma_f32_16x16x32_bf16 v[96:99], v[32:35], v[40:43], v[96:99]
v_mfma_f32_16x16x32_bf16 v[100:103], v[32:35], v[44:47], v[100:103]
v_mfma_f32_16x16x32_bf16 v[104:107], v[32:35], v[48:51], v[104:107]
v_mfma_f32_16x16x32_bf16 v[108:111], v[32:35], v[52:55], v[108:111]
v_mfma_f32_16x16x32_bf16 v[112:115], v[32:35], v[56:59], v[112:115]
v_mfma_f32_16x16x32_bf16 v[116:119], v[36:39], v[40:43], v[116:119]
v_mfma_f32_16x16x32_bf16 v[120:123], v[36:39], v[44:47], v[120:123]
v_mfma_f32_16x16x32_bf16 v[124:127], v[36:39], v[48:51], v[124:127]
v_mfma_f32_16x16x32_bf16 v[128:131], v[36:39], v[52:55], v[128:131]
v_mfma_f32_16x16x32_bf16 v[132:135], v[36:39], v[56:59], v[132:135]
s_add_u32 m0, s36, 113664
s_nop 0
buffer_load_dwordx4 v9, s[8:11], s40 offen lds
s_add_u32 m0, s37, 106496
s_nop 0
buffer_load_dwordx4 v10, s[12:15], s40 offen lds
s_add_u32 m0, s37, 107520
s_nop 0
buffer_load_dwordx4 v11, s[12:15], s40 offen lds
s_waitcnt lgkmcnt(0)
v_mfma_f32_16x16x32_bf16 v[96:99], v[60:63], v[68:71], v[96:99]
v_mfma_f32_16x16x32_bf16 v[100:103], v[60:63], v[72:75], v[100:103]
v_mfma_f32_16x16x32_bf16 v[104:107], v[60:63], v[76:79], v[104:107]
v_mfma_f32_16x16x32_bf16 v[108:111], v[60:63], v[80:83], v[108:111]
v_mfma_f32_16x16x32_bf16 v[112:115], v[60:63], v[84:87], v[112:115]
v_mfma_f32_16x16x32_bf16 v[116:119], v[64:67], v[68:71], v[116:119]
v_mfma_f32_16x16x32_bf16 v[120:123], v[64:67], v[72:75], v[120:123]
v_mfma_f32_16x16x32_bf16 v[124:127], v[64:67], v[76:79], v[124:127]
v_mfma_f32_16x16x32_bf16 v[128:131], v[64:67], v[80:83], v[128:131]
v_mfma_f32_16x16x32_bf16 v[132:135], v[64:67], v[84:87], v[132:135]
s_add_u32 m0, s37, 108544
s_nop 0
buffer_load_dwordx4 v12, s[12:15], s40 offen lds
s_add_u32 m0, s37, 109568
s_nop 0
buffer_load_dwordx4 v13, s[12:15], s40 offen lds
s_add_u32 m0, s37, 110592
s_nop 0
buffer_load_dwordx4 v14, s[12:15], s40 offen lds
s_waitcnt vmcnt(13)
s_barrier
v_add_u32 v88, 53248, v20
v_add_u32 v92, 53248, v24
v_add_u32 v89, 53248, v21
v_add_u32 v93, 53248, v25
v_add_u32 v90, 53248, v22
v_add_u32 v94, 53248, v26
v_add_u32 v91, 53248, v23
v_add_u32 v95, 53248, v27
s_mov_b32 s40, 768
ds_read_b128 v[32:35], v88 offset:0
ds_read_b128 v[36:39], v88 offset:4096
ds_read_b128 v[40:43], v92 offset:0
ds_read_b128 v[44:47], v92 offset:4096
ds_read_b128 v[48:51], v92 offset:8192
ds_read_b128 v[52:55], v92 offset:12288
ds_read_b128 v[56:59], v92 offset:16384
ds_read_b128 v[60:63], v89 offset:0
ds_read_b128 v[64:67], v89 offset:4096
ds_read_b128 v[68:71], v93 offset:0
ds_read_b128 v[72:75], v93 offset:4096
ds_read_b128 v[76:79], v93 offset:8192
ds_read_b128 v[80:83], v93 offset:12288
ds_read_b128 v[84:87], v93 offset:16384
s_waitcnt lgkmcnt(7)
v_mfma_f32_16x16x32_bf16 v[96:99], v[32:35], v[40:43], v[96:99]
v_mfma_f32_16x16x32_bf16 v[100:103], v[32:35], v[44:47], v[100:103]
v_mfma_f32_16x16x32_bf16 v[104:107], v[32:35], v[48:51], v[104:107]
v_mfma_f32_16x16x32_bf16 v[108:111], v[32:35], v[52:55], v[108:111]
v_mfma_f32_16x16x32_bf16 v[112:115], v[32:35], v[56:59], v[112:115]
v_mfma_f32_16x16x32_bf16 v[116:119], v[36:39], v[40:43], v[116:119]
v_mfma_f32_16x16x32_bf16 v[120:123], v[36:39], v[44:47], v[120:123]
v_mfma_f32_16x16x32_bf16 v[124:127], v[36:39], v[48:51], v[124:127]
v_mfma_f32_16x16x32_bf16 v[128:131], v[36:39], v[52:55], v[128:131]
v_mfma_f32_16x16x32_bf16 v[132:135], v[36:39], v[56:59], v[132:135]
s_add_u32 m0, s36, 0
s_nop 0
buffer_load_dwordx4 v2, s[8:11], s40 offen lds
s_add_u32 m0, s36, 1024
s_nop 0
buffer_load_dwordx4 v3, s[8:11], s40 offen lds
s_add_u32 m0, s36, 2048
s_nop 0
buffer_load_dwordx4 v4, s[8:11], s40 offen lds
s_add_u32 m0, s36, 3072
s_nop 0
buffer_load_dwordx4 v5, s[8:11], s40 offen lds
ds_read_b128 v[32:35], v90 offset:0
ds_read_b128 v[36:39], v90 offset:4096
ds_read_b128 v[40:43], v94 offset:0
ds_read_b128 v[44:47], v94 offset:4096
ds_read_b128 v[48:51], v94 offset:8192
ds_read_b128 v[52:55], v94 offset:12288
ds_read_b128 v[56:59], v94 offset:16384
s_waitcnt lgkmcnt(7)
v_mfma_f32_16x16x32_bf16 v[96:99], v[60:63], v[68:71], v[96:99]
v_mfma_f32_16x16x32_bf16 v[100:103], v[60:63], v[72:75], v[100:103]
v_mfma_f32_16x16x32_bf16 v[104:107], v[60:63], v[76:79], v[104:107]
v_mfma_f32_16x16x32_bf16 v[108:111], v[60:63], v[80:83], v[108:111]
v_mfma_f32_16x16x32_bf16 v[112:115], v[60:63], v[84:87], v[112:115]
v_mfma_f32_16x16x32_bf16 v[116:119], v[64:67], v[68:71], v[116:119]
v_mfma_f32_16x16x32_bf16 v[120:123], v[64:67], v[72:75], v[120:123]
v_mfma_f32_16x16x32_bf16 v[124:127], v[64:67], v[76:79], v[124:127]
v_mfma_f32_16x16x32_bf16 v[128:131], v[64:67], v[80:83], v[128:131]
v_mfma_f32_16x16x32_bf16 v[132:135], v[64:67], v[84:87], v[132:135]
s_add_u32 m0, s36, 4096
s_nop 0
buffer_load_dwordx4 v6, s[8:11], s40 offen lds
s_add_u32 m0, s36, 5120
s_nop 0
buffer_load_dwordx4 v7, s[8:11], s40 offen lds
s_add_u32 m0, s36, 6144
s_nop 0
buffer_load_dwordx4 v8, s[8:11], s40 offen lds
ds_read_b128 v[60:63], v91 offset:0
ds_read_b128 v[64:67], v91 offset:4096
ds_read_b128 v[68:71], v95 offset:0
ds_read_b128 v[72:75], v95 offset:4096
ds_read_b128 v[76:79], v95 offset:8192
ds_read_b128 v[80:83], v95 offset:12288
ds_read_b128 v[84:87], v95 offset:16384
s_waitcnt lgkmcnt(7)
v_mfma_f32_16x16x32_bf16 v[96:99], v[32:35], v[40:43], v[96:99]
v_mfma_f32_16x16x32_bf16 v[100:103], v[32:35], v[44:47], v[100:103]
v_mfma_f32_16x16x32_bf16 v[104:107], v[32:35], v[48:51], v[104:107]
v_mfma_f32_16x16x32_bf16 v[108:111], v[32:35], v[52:55], v[108:111]
v_mfma_f32_16x16x32_bf16 v[112:115], v[32:35], v[56:59], v[112:115]
v_mfma_f32_16x16x32_bf16 v[116:119], v[36:39], v[40:43], v[116:119]
v_mfma_f32_16x16x32_bf16 v[120:123], v[36:39], v[44:47], v[120:123]
v_mfma_f32_16x16x32_bf16 v[124:127], v[36:39], v[48:51], v[124:127]
v_mfma_f32_16x16x32_bf16 v[128:131], v[36:39], v[52:55], v[128:131]
v_mfma_f32_16x16x32_bf16 v[132:135], v[36:39], v[56:59], v[132:135]
s_add_u32 m0, s36, 7168
s_nop 0
buffer_load_dwordx4 v9, s[8:11], s40 offen lds
s_add_u32 m0, s37, 0
s_nop 0
buffer_load_dwordx4 v10, s[12:15], s40 offen lds
s_add_u32 m0, s37, 1024
s_nop 0
buffer_load_dwordx4 v11, s[12:15], s40 offen lds
s_waitcnt lgkmcnt(0)
v_mfma_f32_16x16x32_bf16 v[96:99], v[60:63], v[68:71], v[96:99]
v_mfma_f32_16x16x32_bf16 v[100:103], v[60:63], v[72:75], v[100:103]
v_mfma_f32_16x16x32_bf16 v[104:107], v[60:63], v[76:79], v[104:107]
v_mfma_f32_16x16x32_bf16 v[108:111], v[60:63], v[80:83], v[108:111]
v_mfma_f32_16x16x32_bf16 v[112:115], v[60:63], v[84:87], v[112:115]
v_mfma_f32_16x16x32_bf16 v[116:119], v[64:67], v[68:71], v[116:119]
v_mfma_f32_16x16x32_bf16 v[120:123], v[64:67], v[72:75], v[120:123]
v_mfma_f32_16x16x32_bf16 v[124:127], v[64:67], v[76:79], v[124:127]
v_mfma_f32_16x16x32_bf16 v[128:131], v[64:67], v[80:83], v[128:131]
v_mfma_f32_16x16x32_bf16 v[132:135], v[64:67], v[84:87], v[132:135]
s_add_u32 m0, s37, 2048
s_nop 0
buffer_load_dwordx4 v12, s[12:15], s40 offen lds
s_add_u32 m0, s37, 3072
s_nop 0
buffer_load_dwordx4 v13, s[12:15], s40 offen lds
s_add_u32 m0, s37, 4096
s_nop 0
buffer_load_dwordx4 v14, s[12:15], s40 offen lds
s_waitcnt vmcnt(13)
s_barrier
v_add_u32 v88, 106496, v20
v_add_u32 v92, 106496, v24
v_add_u32 v89, 106496, v21
v_add_u32 v93, 106496, v25
v_add_u32 v90, 106496, v22
v_add_u32 v94, 106496, v26
v_add_u32 v91, 106496, v23
v_add_u32 v95, 106496, v27
s_mov_b32 s40, 1024
ds_read_b128 v[32:35], v88 offset:0
ds_read_b128 v[36:39], v88 offset:4096
ds_read_b128 v[40:43], v92 offset:0
ds_read_b128 v[44:47], v92 offset:4096
ds_read_b128 v[48:51], v92 offset:8192
ds_read_b128 v[52:55], v92 offset:12288
ds_read_b128 v[56:59], v92 offset:16384
ds_read_b128 v[60:63], v89 offset:0
ds_read_b128 v[64:67], v89 offset:4096
ds_read_b128 v[68:71], v93 offset:0
ds_read_b128 v[72:75], v93 offset:4096
ds_read_b128 v[76:79], v93 offset:8192
ds_read_b128 v[80:83], v93 offset:12288
ds_read_b128 v[84:87], v93 offset:16384
s_waitcnt lgkmcnt(7)
v_mfma_f32_16x16x32_bf16 v[96:99], v[32:35], v[40:43], v[96:99]
v_mfma_f32_16x16x32_bf16 v[100:103], v[32:35], v[44:47], v[100:103]
v_mfma_f32_16x16x32_bf16 v[104:107], v[32:35], v[48:51], v[104:107]
v_mfma_f32_16x16x32_bf16 v[108:111], v[32:35], v[52:55], v[108:111]
v_mfma_f32_16x16x32_bf16 v[112:115], v[32:35], v[56:59], v[112:115]
v_mfma_f32_16x16x32_bf16 v[116:119], v[36:39], v[40:43], v[116:119]
v_mfma_f32_16x16x32_bf16 v[120:123], v[36:39], v[44:47], v[120:123]
v_mfma_f32_16x16x32_bf16 v[124:127], v[36:39], v[48:51], v[124:127]
v_mfma_f32_16x16x32_bf16 v[128:131], v[36:39], v[52:55], v[128:131]
v_mfma_f32_16x16x32_bf16 v[132:135], v[36:39], v[56:59], v[132:135]
s_add_u32 m0, s36, 53248
s_nop 0
buffer_load_dwordx4 v2, s[8:11], s40 offen lds
s_add_u32 m0, s36, 54272
s_nop 0
buffer_load_dwordx4 v3, s[8:11], s40 offen lds
s_add_u32 m0, s36, 55296
s_nop 0
buffer_load_dwordx4 v4, s[8:11], s40 offen lds
s_add_u32 m0, s36, 56320
s_nop 0
buffer_load_dwordx4 v5, s[8:11], s40 offen lds
ds_read_b128 v[32:35], v90 offset:0
ds_read_b128 v[36:39], v90 offset:4096
ds_read_b128 v[40:43], v94 offset:0
ds_read_b128 v[44:47], v94 offset:4096
ds_read_b128 v[48:51], v94 offset:8192
ds_read_b128 v[52:55], v94 offset:12288
ds_read_b128 v[56:59], v94 offset:16384
s_waitcnt lgkmcnt(7)
v_mfma_f32_16x16x32_bf16 v[96:99], v[60:63], v[68:71], v[96:99]
v_mfma_f32_16x16x32_bf16 v[100:103], v[60:63], v[72:75], v[100:103]
v_mfma_f32_16x16x32_bf16 v[104:107], v[60:63], v[76:79], v[104:107]
v_mfma_f32_16x16x32_bf16 v[108:111], v[60:63], v[80:83], v[108:111]
v_mfma_f32_16x16x32_bf16 v[112:115], v[60:63], v[84:87], v[112:115]
v_mfma_f32_16x16x32_bf16 v[116:119], v[64:67], v[68:71], v[116:119]
v_mfma_f32_16x16x32_bf16 v[120:123], v[64:67], v[72:75], v[120:123]
v_mfma_f32_16x16x32_bf16 v[124:127], v[64:67], v[76:79], v[124:127]
v_mfma_f32_16x16x32_bf16 v[128:131], v[64:67], v[80:83], v[128:131]
v_mfma_f32_16x16x32_bf16 v[132:135], v[64:67], v[84:87], v[132:135]
s_add_u32 m0, s36, 57344
s_nop 0
buffer_load_dwordx4 v6, s[8:11], s40 offen lds
s_add_u32 m0, s36, 58368
s_nop 0
buffer_load_dwordx4 v7, s[8:11], s40 offen lds
s_add_u32 m0, s36, 59392
s_nop 0
buffer_load_dwordx4 v8, s[8:11], s40 offen lds
ds_read_b128 v[60:63], v91 offset:0
ds_read_b128 v[64:67], v91 offset:4096
ds_read_b128 v[68:71], v95 offset:0
ds_read_b128 v[72:75], v95 offset:4096
ds_read_b128 v[76:79], v95 offset:8192
ds_read_b128 v[80:83], v95 offset:12288
ds_read_b128 v[84:87], v95 offset:16384
s_waitcnt lgkmcnt(7)
v_mfma_f32_16x16x32_bf16 v[96:99], v[32:35], v[40:43], v[96:99]
v_mfma_f32_16x16x32_bf16 v[100:103], v[32:35], v[44:47], v[100:103]
v_mfma_f32_16x16x32_bf16 v[104:107], v[32:35], v[48:51], v[104:107]
v_mfma_f32_16x16x32_bf16 v[108:111], v[32:35], v[52:55], v[108:111]
v_mfma_f32_16x16x32_bf16 v[112:115], v[32:35], v[56:59], v[112:115]
v_mfma_f32_16x16x32_bf16 v[116:119], v[36:39], v[40:43], v[116:119]
v_mfma_f32_16x16x32_bf16 v[120:123], v[36:39], v[44:47], v[120:123]
v_mfma_f32_16x16x32_bf16 v[124:127], v[36:39], v[48:51], v[124:127]
v_mfma_f32_16x16x32_bf16 v[128:131], v[36:39], v[52:55], v[128:131]
v_mfma_f32_16x16x32_bf16 v[132:135], v[36:39], v[56:59], v[132:135]
s_add_u32 m0, s36, 60416
s_nop 0
buffer_load_dwordx4 v9, s[8:11], s40 offen lds
s_add_u32 m0, s37, 53248
s_nop 0
buffer_load_dwordx4 v10, s[12:15], s40 offen lds
s_add_u32 m0, s37, 54272
s_nop 0
buffer_load_dwordx4 v11, s[12:15], s40 offen lds
s_waitcnt lgkmcnt(0)
v_mfma_f32_16x16x32_bf16 v[96:99], v[60:63], v[68:71], v[96:99]
v_mfma_f32_16x16x32_bf16 v[100:103], v[60:63], v[72:75], v[100:103]
v_mfma_f32_16x16x32_bf16 v[104:107], v[60:63], v[76:79], v[104:107]
v_mfma_f32_16x16x32_bf16 v[108:111], v[60:63], v[80:83], v[108:111]
v_mfma_f32_16x16x32_bf16 v[112:115], v[60:63], v[84:87], v[112:115]
v_mfma_f32_16x16x32_bf16 v[116:119], v[64:67], v[68:71], v[116:119]
v_mfma_f32_16x16x32_bf16 v[120:123], v[64:67], v[72:75], v[120:123]
v_mfma_f32_16x16x32_bf16 v[124:127], v[64:67], v[76:79], v[124:127]
v_mfma_f32_16x16x32_bf16 v[128:131], v[64:67], v[80:83], v[128:131]
v_mfma_f32_16x16x32_bf16 v[132:135], v[64:67], v[84:87], v[132:135]
s_add_u32 m0, s37, 55296
s_nop 0
buffer_load_dwordx4 v12, s[12:15], s40 offen lds
s_add_u32 m0, s37, 56320
s_nop 0
buffer_load_dwordx4 v13, s[12:15], s40 offen lds
s_add_u32 m0, s37, 57344
s_nop 0
buffer_load_dwordx4 v14, s[12:15], s40 offen lds
s_waitcnt vmcnt(13)
s_barrier
v_add_u32 v88, 0, v20
v_add_u32 v92, 0, v24
v_add_u32 v89, 0, v21
v_add_u32 v93, 0, v25
v_add_u32 v90, 0, v22
v_add_u32 v94, 0, v26
v_add_u32 v91, 0, v23
v_add_u32 v95, 0, v27
ds_read_b128 v[32:35], v88 offset:0
ds_read_b128 v[36:39], v88 offset:4096
ds_read_b128 v[40:43], v92 offset:0
ds_read_b128 v[44:47], v92 offset:4096
ds_read_b128 v[48:51], v92 offset:8192
ds_read_b128 v[52:55], v92 offset:12288
ds_read_b128 v[56:59], v92 offset:16384
ds_read_b128 v[60:63], v89 offset:0
ds_read_b128 v[64:67], v89 offset:4096
ds_read_b128 v[68:71], v93 offset:0
ds_read_b128 v[72:75], v93 offset:4096
ds_read_b128 v[76:79], v93 offset:8192
ds_read_b128 v[80:83], v93 offset:12288
ds_read_b128 v[84:87], v93 offset:16384
s_waitcnt lgkmcnt(7)
v_mfma_f32_16x16x32_bf16 v[96:99], v[32:35], v[40:43], v[96:99]
v_mfma_f32_16x16x32_bf16 v[100:103], v[32:35], v[44:47], v[100:103]
v_mfma_f32_16x16x32_bf16 v[104:107], v[32:35], v[48:51], v[104:107]
v_mfma_f32_16x16x32_bf16 v[108:111], v[32:35], v[52:55], v[108:111]
v_mfma_f32_16x16x32_bf16 v[112:115], v[32:35], v[56:59], v[112:115]
v_mfma_f32_16x16x32_bf16 v[116:119], v[36:39], v[40:43], v[116:119]
v_mfma_f32_16x16x32_bf16 v[120:123], v[36:39], v[44:47], v[120:123]
v_mfma_f32_16x16x32_bf16 v[124:127], v[36:39], v[48:51], v[124:127]
v_mfma_f32_16x16x32_bf16 v[128:131], v[36:39], v[52:55], v[128:131]
v_mfma_f32_16x16x32_bf16 v[132:135], v[36:39], v[56:59], v[132:135]
ds_read_b128 v[32:35], v90 offset:0
ds_read_b128 v[36:39], v90 offset:4096
ds_read_b128 v[40:43], v94 offset:0
ds_read_b128 v[44:47], v94 offset:4096
ds_read_b128 v[48:51], v94 offset:8192
ds_read_b128 v[52:55], v94 offset:12288
ds_read_b128 v[56:59], v94 offset:16384
s_waitcnt lgkmcnt(7)
v_mfma_f32_16x16x32_bf16 v[96:99], v[60:63], v[68:71], v[96:99]
v_mfma_f32_16x16x32_bf16 v[100:103], v[60:63], v[72:75], v[100:103]
v_mfma_f32_16x16x32_bf16 v[104:107], v[60:63], v[76:79], v[104:107]
v_mfma_f32_16x16x32_bf16 v[108:111], v[60:63], v[80:83], v[108:111]
v_mfma_f32_16x16x32_bf16 v[112:115], v[60:63], v[84:87], v[112:115]
v_mfma_f32_16x16x32_bf16 v[116:119], v[64:67], v[68:71], v[116:119]
v_mfma_f32_16x16x32_bf16 v[120:123], v[64:67], v[72:75], v[120:123]
v_mfma_f32_16x16x32_bf16 v[124:127], v[64:67], v[76:79], v[124:127]
v_mfma_f32_16x16x32_bf16 v[128:131], v[64:67], v[80:83], v[128:131]
v_mfma_f32_16x16x32_bf16 v[132:135], v[64:67], v[84:87], v[132:135]
ds_read_b128 v[60:63], v91 offset:0
ds_read_b128 v[64:67], v91 offset:4096
ds_read_b128 v[68:71], v95 offset:0
ds_read_b128 v[72:75], v95 offset:4096
ds_read_b128 v[76:79], v95 offset:8192
ds_read_b128 v[80:83], v95 offset:12288
ds_read_b128 v[84:87], v95 offset:16384
s_waitcnt lgkmcnt(7)
v_mfma_f32_16x16x32_bf16 v[96:99], v[32:35], v[40:43], v[96:99]
v_mfma_f32_16x16x32_bf16 v[100:103], v[32:35], v[44:47], v[100:103]
v_mfma_f32_16x16x32_bf16 v[104:107], v[32:35], v[48:51], v[104:107]
v_mfma_f32_16x16x32_bf16 v[108:111], v[32:35], v[52:55], v[108:111]
v_mfma_f32_16x16x32_bf16 v[112:115], v[32:35], v[56:59], v[112:115]
v_mfma_f32_16x16x32_bf16 v[116:119], v[36:39], v[40:43], v[116:119]
v_mfma_f32_16x16x32_bf16 v[120:123], v[36:39], v[44:47], v[120:123]
v_mfma_f32_16x16x32_bf16 v[124:127], v[36:39], v[48:51], v[124:127]
v_mfma_f32_16x16x32_bf16 v[128:131], v[36:39], v[52:55], v[128:131]
v_mfma_f32_16x16x32_bf16 v[132:135], v[36:39], v[56:59], v[132:135]
s_waitcnt lgkmcnt(0)
v_mfma_f32_16x16x32_bf16 v[96:99], v[60:63], v[68:71], v[96:99]
v_mfma_f32_16x16x32_bf16 v[100:103], v[60:63], v[72:75], v[100:103]
v_mfma_f32_16x16x32_bf16 v[104:107], v[60:63], v[76:79], v[104:107]
v_mfma_f32_16x16x32_bf16 v[108:111], v[60:63], v[80:83], v[108:111]
v_mfma_f32_16x16x32_bf16 v[112:115], v[60:63], v[84:87], v[112:115]
v_mfma_f32_16x16x32_bf16 v[116:119], v[64:67], v[68:71], v[116:119]
v_mfma_f32_16x16x32_bf16 v[120:123], v[64:67], v[72:75], v[120:123]
v_mfma_f32_16x16x32_bf16 v[124:127], v[64:67], v[76:79], v[124:127]
v_mfma_f32_16x16x32_bf16 v[128:131], v[64:67], v[80:83], v[128:131]
v_mfma_f32_16x16x32_bf16 v[132:135], v[64:67], v[84:87], v[132:135]
s_waitcnt vmcnt(0)
s_barrier
v_add_u32 v88, 53248, v20
v_add_u32 v92, 53248, v24
v_add_u32 v89, 53248, v21
v_add_u32 v93, 53248, v25
v_add_u32 v90, 53248, v22
v_add_u32 v94, 53248, v26
v_add_u32 v91, 53248, v23
v_add_u32 v95, 53248, v27
ds_read_b128 v[32:35], v88 offset:0
ds_read_b128 v[36:39], v88 offset:4096
ds_read_b128 v[40:43], v92 offset:0
ds_read_b128 v[44:47], v92 offset:4096
ds_read_b128 v[48:51], v92 offset:8192
ds_read_b128 v[52:55], v92 offset:12288
ds_read_b128 v[56:59], v92 offset:16384
ds_read_b128 v[60:63], v89 offset:0
ds_read_b128 v[64:67], v89 offset:4096
ds_read_b128 v[68:71], v93 offset:0
ds_read_b128 v[72:75], v93 offset:4096
ds_read_b128 v[76:79], v93 offset:8192
ds_read_b128 v[80:83], v93 offset:12288
ds_read_b128 v[84:87], v93 offset:16384
s_waitcnt lgkmcnt(7)
v_mfma_f32_16x16x32_bf16 v[96:99], v[32:35], v[40:43], v[96:99]
v_mfma_f32_16x16x32_bf16 v[100:103], v[32:35], v[44:47], v[100:103]
v_mfma_f32_16x16x32_bf16 v[104:107], v[32:35], v[48:51], v[104:107]
v_mfma_f32_16x16x32_bf16 v[108:111], v[32:35], v[52:55], v[108:111]
v_mfma_f32_16x16x32_bf16 v[112:115], v[32:35], v[56:59], v[112:115]
v_mfma_f32_16x16x32_bf16 v[116:119], v[36:39], v[40:43], v[116:119]
v_mfma_f32_16x16x32_bf16 v[120:123], v[36:39], v[44:47], v[120:123]
v_mfma_f32_16x16x32_bf16 v[124:127], v[36:39], v[48:51], v[124:127]
v_mfma_f32_16x16x32_bf16 v[128:131], v[36:39], v[52:55], v[128:131]
v_mfma_f32_16x16x32_bf16 v[132:135], v[36:39], v[56:59], v[132:135]
ds_read_b128 v[32:35], v90 offset:0
ds_read_b128 v[36:39], v90 offset:4096
ds_read_b128 v[40:43], v94 offset:0
ds_read_b128 v[44:47], v94 offset:4096
ds_read_b128 v[48:51], v94 offset:8192
ds_read_b128 v[52:55], v94 offset:12288
ds_read_b128 v[56:59], v94 offset:16384
s_waitcnt lgkmcnt(7)
v_mfma_f32_16x16x32_bf16 v[96:99], v[60:63], v[68:71], v[96:99]
v_mfma_f32_16x16x32_bf16 v[100:103], v[60:63], v[72:75], v[100:103]
v_mfma_f32_16x16x32_bf16 v[104:107], v[60:63], v[76:79], v[104:107]
v_mfma_f32_16x16x32_bf16 v[108:111], v[60:63], v[80:83], v[108:111]
v_mfma_f32_16x16x32_bf16 v[112:115], v[60:63], v[84:87], v[112:115]
v_mfma_f32_16x16x32_bf16 v[116:119], v[64:67], v[68:71], v[116:119]
v_mfma_f32_16x16x32_bf16 v[120:123], v[64:67], v[72:75], v[120:123]
v_mfma_f32_16x16x32_bf16 v[124:127], v[64:67], v[76:79], v[124:127]
v_mfma_f32_16x16x32_bf16 v[128:131], v[64:67], v[80:83], v[128:131]
v_mfma_f32_16x16x32_bf16 v[132:135], v[64:67], v[84:87], v[132:135]
ds_read_b128 v[60:63], v91 offset:0
ds_read_b128 v[64:67], v91 offset:4096
ds_read_b128 v[68:71], v95 offset:0
ds_read_b128 v[72:75], v95 offset:4096
ds_read_b128 v[76:79], v95 offset:8192
ds_read_b128 v[80:83], v95 offset:12288
ds_read_b128 v[84:87], v95 offset:16384
s_waitcnt lgkmcnt(7)
v_mfma_f32_16x16x32_bf16 v[96:99], v[32:35], v[40:43], v[96:99]
v_mfma_f32_16x16x32_bf16 v[100:103], v[32:35], v[44:47], v[100:103]
v_mfma_f32_16x16x32_bf16 v[104:107], v[32:35], v[48:51], v[104:107]
v_mfma_f32_16x16x32_bf16 v[108:111], v[32:35], v[52:55], v[108:111]
v_mfma_f32_16x16x32_bf16 v[112:115], v[32:35], v[56:59], v[112:115]
v_mfma_f32_16x16x32_bf16 v[116:119], v[36:39], v[40:43], v[116:119]
v_mfma_f32_16x16x32_bf16 v[120:123], v[36:39], v[44:47], v[120:123]
v_mfma_f32_16x16x32_bf16 v[124:127], v[36:39], v[48:51], v[124:127]
v_mfma_f32_16x16x32_bf16 v[128:131], v[36:39], v[52:55], v[128:131]
v_mfma_f32_16x16x32_bf16 v[132:135], v[36:39], v[56:59], v[132:135]
s_waitcnt lgkmcnt(0)
v_mfma_f32_16x16x32_bf16 v[96:99], v[60:63], v[68:71], v[96:99]
v_mfma_f32_16x16x32_bf16 v[100:103], v[60:63], v[72:75], v[100:103]
v_mfma_f32_16x16x32_bf16 v[104:107], v[60:63], v[76:79], v[104:107]
v_mfma_f32_16x16x32_bf16 v[108:111], v[60:63], v[80:83], v[108:111]
v_mfma_f32_16x16x32_bf16 v[112:115], v[60:63], v[84:87], v[112:115]
v_mfma_f32_16x16x32_bf16 v[116:119], v[64:67], v[68:71], v[116:119]
v_mfma_f32_16x16x32_bf16 v[120:123], v[64:67], v[72:75], v[120:123]
v_mfma_f32_16x16x32_bf16 v[124:127], v[64:67], v[76:79], v[124:127]
v_mfma_f32_16x16x32_bf16 v[128:131], v[64:67], v[80:83], v[128:131]
v_mfma_f32_16x16x32_bf16 v[132:135], v[64:67], v[84:87], v[132:135]
s_nop 7
s_nop 7
v_lshlrev_b32 v30, 12, v17
v_lshlrev_b32 v31, 3, v16
v_add_u32 v30, v30, v31
s_lshl_b32 s38, s35, 6
v_add_u32 v30, s38, v30
v_cvt_pk_bf16_f32 v32, v96, v97
v_cvt_pk_bf16_f32 v33, v98, v99
s_mov_b32 s41, 0
buffer_store_dwordx2 v[32:33], v30, s[16:19], s41 offen
s_nop 1
v_cvt_pk_bf16_f32 v32, v100, v101
v_cvt_pk_bf16_f32 v33, v102, v103
s_mov_b32 s41, 65536
buffer_store_dwordx2 v[32:33], v30, s[16:19], s41 offen
s_nop 1
v_cvt_pk_bf16_f32 v32, v104, v105
v_cvt_pk_bf16_f32 v33, v106, v107
s_mov_b32 s41, 131072
buffer_store_dwordx2 v[32:33], v30, s[16:19], s41 offen
s_nop 1
v_cvt_pk_bf16_f32 v32, v108, v109
v_cvt_pk_bf16_f32 v33, v110, v111
s_mov_b32 s41, 196608
buffer_store_dwordx2 v[32:33], v30, s[16:19], s41 offen
s_nop 1
v_cvt_pk_bf16_f32 v32, v112, v113
v_cvt_pk_bf16_f32 v33, v114, v115
s_mov_b32 s41, 262144
buffer_store_dwordx2 v[32:33], v30, s[16:19], s41 offen
s_nop 1
v_cvt_pk_bf16_f32 v32, v116, v117
v_cvt_pk_bf16_f32 v33, v118, v119
s_mov_b32 s41, 32
buffer_store_dwordx2 v[32:33], v30, s[16:19], s41 offen
s_nop 1
v_cvt_pk_bf16_f32 v32, v120, v121
v_cvt_pk_bf16_f32 v33, v122, v123
s_mov_b32 s41, 65568
buffer_store_dwordx2 v[32:33], v30, s[16:19], s41 offen
s_nop 1
v_cvt_pk_bf16_f32 v32, v124, v125
v_cvt_pk_bf16_f32 v33, v126, v127
s_mov_b32 s41, 131104
buffer_store_dwordx2 v[32:33], v30, s[16:19], s41 offen
s_nop 1
v_cvt_pk_bf16_f32 v32, v128, v129
v_cvt_pk_bf16_f32 v33, v130, v131
s_mov_b32 s41, 196640
buffer_store_dwordx2 v[32:33], v30, s[16:19], s41 offen
s_nop 1
v_cvt_pk_bf16_f32 v32, v132, v133
v_cvt_pk_bf16_f32 v33, v134, v135
s_mov_b32 s41, 262176
buffer_store_dwordx2 v[32:33], v30, s[16:19], s41 offen
s_nop 1
g1_kernel_done:
s_endpgm
.p2align 8
g2_kernel:
s_cmp_ge_u32 s2, 256
s_cbranch_scc1 g2_kernel_done
s_load_dwordx4 s[24:27], s[0:1], 56
s_load_dwordx2 s[28:29], s[0:1], 104
s_waitcnt lgkmcnt(0)
s_and_b32 s30, s2, 7
s_lshr_b32 s31, s2, 3
s_lshl_b32 s30, s30, 2
s_lshr_b32 s32, s31, 3
s_add_u32 s30, s30, s32
s_and_b32 s31, s31, 7
s_lshr_b32 s33, s30, 4
s_and_b32 s30, s30, 15
s_cmp_eq_u32 s33, 1
s_cselect_b32 s4, s26, s24
s_cselect_b32 s5, s27, s25
s_lshl_b32 s32, s30, 19
s_add_u32 s4, s4, s32
s_addc_u32 s5, s5, 0
s_mul_i32 s32, s33, 2621440
s_mul_i32 s34, s31, 80*4096
s_add_u32 s34, s34, s32
s_add_u32 s6, s28, s34
s_addc_u32 s7, s29, 0
s_mul_i32 s34, s30, 128*1280
s_add_u32 s32, s32, s34
s_mul_i32 s34, s31, 160
s_add_u32 s32, s32, s34
s_add_u32 s32, s32, 0x800000
s_add_u32 s28, s28, s32
s_addc_u32 s29, s29, 0
s_mov_b32 s8, s4
s_and_b32 s9, s5, 0xffff
s_mov_b32 s10, 0x7fffffff
s_mov_b32 s11, 0x20000
s_mov_b32 s12, s6
s_and_b32 s13, s7, 0xffff
s_mov_b32 s14, 0x7fffffff
s_mov_b32 s15, 0x20000
s_mov_b32 s16, s28
s_and_b32 s17, s29, 0xffff
s_mov_b32 s18, 0x7fffffff
s_mov_b32 s19, 0x20000
v_and_b32 v1, 63, v0
v_lshrrev_b32 v15, 6, v0
s_nop 0
v_readfirstlane_b32 s35, v15
s_lshl_b32 s36, s35, 13
s_mul_i32 s37, s35, 5120
s_add_u32 s37, s37, 32768
v_lshrrev_b32 v16, 4, v1
v_and_b32 v17, 15, v1
s_lshl_b32 s38, s35, 5
s_add_u32 s38, s38, 0
v_add_u32 v18, s38, v16
v_and_b32 v19, 15, v18
v_xor_b32 v19, v19, v17
v_lshlrev_b32 v19, 4, v19
s_mov_b32 s39, 4096
v_mul_lo_u32 v18, v18, s39
v_add_u32 v2, v18, v19
s_lshl_b32 s38, s35, 5
s_add_u32 s38, s38, 4
v_add_u32 v18, s38, v16
v_and_b32 v19, 15, v18
v_xor_b32 v19, v19, v17
v_lshlrev_b32 v19, 4, v19
s_mov_b32 s39, 4096
v_mul_lo_u32 v18, v18, s39
v_add_u32 v3, v18, v19
s_lshl_b32 s38, s35, 5
s_add_u32 s38, s38, 8
v_add_u32 v18, s38, v16
v_and_b32 v19, 15, v18
v_xor_b32 v19, v19, v17
v_lshlrev_b32 v19, 4, v19
s_mov_b32 s39, 4096
v_mul_lo_u32 v18, v18, s39
v_add_u32 v4, v18, v19
s_lshl_b32 s38, s35, 5
s_add_u32 s38, s38, 12
v_add_u32 v18, s38, v16
v_and_b32 v19, 15, v18
v_xor_b32 v19, v19, v17
v_lshlrev_b32 v19, 4, v19
s_mov_b32 s39, 4096
v_mul_lo_u32 v18, v18, s39
v_add_u32 v5, v18, v19
s_lshl_b32 s38, s35, 5
s_add_u32 s38, s38, 16
v_add_u32 v18, s38, v16
v_and_b32 v19, 15, v18
v_xor_b32 v19, v19, v17
v_lshlrev_b32 v19, 4, v19
s_mov_b32 s39, 4096
v_mul_lo_u32 v18, v18, s39
v_add_u32 v6, v18, v19
s_lshl_b32 s38, s35, 5
s_add_u32 s38, s38, 20
v_add_u32 v18, s38, v16
v_and_b32 v19, 15, v18
v_xor_b32 v19, v19, v17
v_lshlrev_b32 v19, 4, v19
s_mov_b32 s39, 4096
v_mul_lo_u32 v18, v18, s39
v_add_u32 v7, v18, v19
s_lshl_b32 s38, s35, 5
s_add_u32 s38, s38, 24
v_add_u32 v18, s38, v16
v_and_b32 v19, 15, v18
v_xor_b32 v19, v19, v17
v_lshlrev_b32 v19, 4, v19
s_mov_b32 s39, 4096
v_mul_lo_u32 v18, v18, s39
v_add_u32 v8, v18, v19
s_lshl_b32 s38, s35, 5
s_add_u32 s38, s38, 28
v_add_u32 v18, s38, v16
v_and_b32 v19, 15, v18
v_xor_b32 v19, v19, v17
v_lshlrev_b32 v19, 4, v19
s_mov_b32 s39, 4096
v_mul_lo_u32 v18, v18, s39
v_add_u32 v9, v18, v19
s_mul_i32 s38, s35, 20
s_add_u32 s38, s38, 0
v_add_u32 v18, s38, v16
v_and_b32 v19, 15, v18
v_xor_b32 v19, v19, v17
v_lshlrev_b32 v19, 4, v19
s_mov_b32 s39, 4096
v_mul_lo_u32 v18, v18, s39
v_add_u32 v10, v18, v19
s_mul_i32 s38, s35, 20
s_add_u32 s38, s38, 4
v_add_u32 v18, s38, v16
v_and_b32 v19, 15, v18
v_xor_b32 v19, v19, v17
v_lshlrev_b32 v19, 4, v19
s_mov_b32 s39, 4096
v_mul_lo_u32 v18, v18, s39
v_add_u32 v11, v18, v19
s_mul_i32 s38, s35, 20
s_add_u32 s38, s38, 8
v_add_u32 v18, s38, v16
v_and_b32 v19, 15, v18
v_xor_b32 v19, v19, v17
v_lshlrev_b32 v19, 4, v19
s_mov_b32 s39, 4096
v_mul_lo_u32 v18, v18, s39
v_add_u32 v12, v18, v19
s_mul_i32 s38, s35, 20
s_add_u32 s38, s38, 12
v_add_u32 v18, s38, v16
v_and_b32 v19, 15, v18
v_xor_b32 v19, v19, v17
v_lshlrev_b32 v19, 4, v19
s_mov_b32 s39, 4096
v_mul_lo_u32 v18, v18, s39
v_add_u32 v13, v18, v19
s_mul_i32 s38, s35, 20
s_add_u32 s38, s38, 16
v_add_u32 v18, s38, v16
v_and_b32 v19, 15, v18
v_xor_b32 v19, v19, v17
v_lshlrev_b32 v19, 4, v19
s_mov_b32 s39, 4096
v_mul_lo_u32 v18, v18, s39
v_add_u32 v14, v18, v19
v_lshrrev_b32 v18, 2, v17
v_and_b32 v19, 3, v17
v_xor_b32 v19, v19, v16
v_lshlrev_b32 v28, 8, v17
s_lshl_b32 s38, s35, 13
v_add_u32 v29, s38, v28
v_xor_b32 v30, 0, v18
v_lshlrev_b32 v30, 2, v30
v_or_b32 v30, v30, v19
v_lshlrev_b32 v30, 4, v30
v_add_u32 v20, v29, v30
v_add_u32 v24, v28, v30
v_add_u32 v24, 32768, v24
v_xor_b32 v30, 1, v18
v_lshlrev_b32 v30, 2, v30
v_or_b32 v30, v30, v19
v_lshlrev_b32 v30, 4, v30
v_add_u32 v21, v29, v30
v_add_u32 v25, v28, v30
v_add_u32 v25, 32768, v25
v_xor_b32 v30, 2, v18
v_lshlrev_b32 v30, 2, v30
v_or_b32 v30, v30, v19
v_lshlrev_b32 v30, 4, v30
v_add_u32 v22, v29, v30
v_add_u32 v26, v28, v30
v_add_u32 v26, 32768, v26
v_xor_b32 v30, 3, v18
v_lshlrev_b32 v30, 2, v30
v_or_b32 v30, v30, v19
v_lshlrev_b32 v30, 4, v30
v_add_u32 v23, v29, v30
v_add_u32 v27, v28, v30
v_add_u32 v27, 32768, v27
v_mov_b32 v96, 0
v_mov_b32 v97, 0
v_mov_b32 v98, 0
v_mov_b32 v99, 0
v_mov_b32 v100, 0
v_mov_b32 v101, 0
v_mov_b32 v102, 0
v_mov_b32 v103, 0
v_mov_b32 v104, 0
v_mov_b32 v105, 0
v_mov_b32 v106, 0
v_mov_b32 v107, 0
v_mov_b32 v108, 0
v_mov_b32 v109, 0
v_mov_b32 v110, 0
v_mov_b32 v111, 0
v_mov_b32 v112, 0
v_mov_b32 v113, 0
v_mov_b32 v114, 0
v_mov_b32 v115, 0
v_mov_b32 v116, 0
v_mov_b32 v117, 0
v_mov_b32 v118, 0
v_mov_b32 v119, 0
v_mov_b32 v120, 0
v_mov_b32 v121, 0
v_mov_b32 v122, 0
v_mov_b32 v123, 0
v_mov_b32 v124, 0
v_mov_b32 v125, 0
v_mov_b32 v126, 0
v_mov_b32 v127, 0
v_mov_b32 v128, 0
v_mov_b32 v129, 0
v_mov_b32 v130, 0
v_mov_b32 v131, 0
v_mov_b32 v132, 0
v_mov_b32 v133, 0
v_mov_b32 v134, 0
v_mov_b32 v135, 0
s_mov_b32 s40, 0
s_add_u32 m0, s36, 0
s_nop 0
buffer_load_dwordx4 v2, s[8:11], s40 offen lds
s_add_u32 m0, s36, 1024
s_nop 0
buffer_load_dwordx4 v3, s[8:11], s40 offen lds
s_add_u32 m0, s36, 2048
s_nop 0
buffer_load_dwordx4 v4, s[8:11], s40 offen lds
s_add_u32 m0, s36, 3072
s_nop 0
buffer_load_dwordx4 v5, s[8:11], s40 offen lds
s_add_u32 m0, s36, 4096
s_nop 0
buffer_load_dwordx4 v6, s[8:11], s40 offen lds
s_add_u32 m0, s36, 5120
s_nop 0
buffer_load_dwordx4 v7, s[8:11], s40 offen lds
s_add_u32 m0, s36, 6144
s_nop 0
buffer_load_dwordx4 v8, s[8:11], s40 offen lds
s_add_u32 m0, s36, 7168
s_nop 0
buffer_load_dwordx4 v9, s[8:11], s40 offen lds
s_add_u32 m0, s37, 0
s_nop 0
buffer_load_dwordx4 v10, s[12:15], s40 offen lds
s_add_u32 m0, s37, 1024
s_nop 0
buffer_load_dwordx4 v11, s[12:15], s40 offen lds
s_add_u32 m0, s37, 2048
s_nop 0
buffer_load_dwordx4 v12, s[12:15], s40 offen lds
s_add_u32 m0, s37, 3072
s_nop 0
buffer_load_dwordx4 v13, s[12:15], s40 offen lds
s_add_u32 m0, s37, 4096
s_nop 0
buffer_load_dwordx4 v14, s[12:15], s40 offen lds
s_mov_b32 s40, 256
s_add_u32 m0, s36, 53248
s_nop 0
buffer_load_dwordx4 v2, s[8:11], s40 offen lds
s_add_u32 m0, s36, 54272
s_nop 0
buffer_load_dwordx4 v3, s[8:11], s40 offen lds
s_add_u32 m0, s36, 55296
s_nop 0
buffer_load_dwordx4 v4, s[8:11], s40 offen lds
s_add_u32 m0, s36, 56320
s_nop 0
buffer_load_dwordx4 v5, s[8:11], s40 offen lds
s_add_u32 m0, s36, 57344
s_nop 0
buffer_load_dwordx4 v6, s[8:11], s40 offen lds
s_add_u32 m0, s36, 58368
s_nop 0
buffer_load_dwordx4 v7, s[8:11], s40 offen lds
s_add_u32 m0, s36, 59392
s_nop 0
buffer_load_dwordx4 v8, s[8:11], s40 offen lds
s_add_u32 m0, s36, 60416
s_nop 0
buffer_load_dwordx4 v9, s[8:11], s40 offen lds
s_add_u32 m0, s37, 53248
s_nop 0
buffer_load_dwordx4 v10, s[12:15], s40 offen lds
s_add_u32 m0, s37, 54272
s_nop 0
buffer_load_dwordx4 v11, s[12:15], s40 offen lds
s_add_u32 m0, s37, 55296
s_nop 0
buffer_load_dwordx4 v12, s[12:15], s40 offen lds
s_add_u32 m0, s37, 56320
s_nop 0
buffer_load_dwordx4 v13, s[12:15], s40 offen lds
s_add_u32 m0, s37, 57344
s_nop 0
buffer_load_dwordx4 v14, s[12:15], s40 offen lds
s_waitcnt vmcnt(13)
s_barrier
v_add_u32 v88, 0, v20
v_add_u32 v92, 0, v24
v_add_u32 v89, 0, v21
v_add_u32 v93, 0, v25
v_add_u32 v90, 0, v22
v_add_u32 v94, 0, v26
v_add_u32 v91, 0, v23
v_add_u32 v95, 0, v27
s_mov_b32 s40, 512
ds_read_b128 v[32:35], v88 offset:0
ds_read_b128 v[36:39], v88 offset:4096
ds_read_b128 v[40:43], v92 offset:0
ds_read_b128 v[44:47], v92 offset:4096
ds_read_b128 v[48:51], v92 offset:8192
ds_read_b128 v[52:55], v92 offset:12288
ds_read_b128 v[56:59], v92 offset:16384
ds_read_b128 v[60:63], v89 offset:0
ds_read_b128 v[64:67], v89 offset:4096
ds_read_b128 v[68:71], v93 offset:0
ds_read_b128 v[72:75], v93 offset:4096
ds_read_b128 v[76:79], v93 offset:8192
ds_read_b128 v[80:83], v93 offset:12288
ds_read_b128 v[84:87], v93 offset:16384
s_waitcnt lgkmcnt(7)
v_mfma_f32_16x16x32_bf16 v[96:99], v[32:35], v[40:43], v[96:99]
v_mfma_f32_16x16x32_bf16 v[100:103], v[32:35], v[44:47], v[100:103]
v_mfma_f32_16x16x32_bf16 v[104:107], v[32:35], v[48:51], v[104:107]
v_mfma_f32_16x16x32_bf16 v[108:111], v[32:35], v[52:55], v[108:111]
v_mfma_f32_16x16x32_bf16 v[112:115], v[32:35], v[56:59], v[112:115]
v_mfma_f32_16x16x32_bf16 v[116:119], v[36:39], v[40:43], v[116:119]
v_mfma_f32_16x16x32_bf16 v[120:123], v[36:39], v[44:47], v[120:123]
v_mfma_f32_16x16x32_bf16 v[124:127], v[36:39], v[48:51], v[124:127]
v_mfma_f32_16x16x32_bf16 v[128:131], v[36:39], v[52:55], v[128:131]
v_mfma_f32_16x16x32_bf16 v[132:135], v[36:39], v[56:59], v[132:135]
s_add_u32 m0, s36, 106496
s_nop 0
buffer_load_dwordx4 v2, s[8:11], s40 offen lds
s_add_u32 m0, s36, 107520
s_nop 0
buffer_load_dwordx4 v3, s[8:11], s40 offen lds
s_add_u32 m0, s36, 108544
s_nop 0
buffer_load_dwordx4 v4, s[8:11], s40 offen lds
s_add_u32 m0, s36, 109568
s_nop 0
buffer_load_dwordx4 v5, s[8:11], s40 offen lds
ds_read_b128 v[32:35], v90 offset:0
ds_read_b128 v[36:39], v90 offset:4096
ds_read_b128 v[40:43], v94 offset:0
ds_read_b128 v[44:47], v94 offset:4096
ds_read_b128 v[48:51], v94 offset:8192
ds_read_b128 v[52:55], v94 offset:12288
ds_read_b128 v[56:59], v94 offset:16384
s_waitcnt lgkmcnt(7)
v_mfma_f32_16x16x32_bf16 v[96:99], v[60:63], v[68:71], v[96:99]
v_mfma_f32_16x16x32_bf16 v[100:103], v[60:63], v[72:75], v[100:103]
v_mfma_f32_16x16x32_bf16 v[104:107], v[60:63], v[76:79], v[104:107]
v_mfma_f32_16x16x32_bf16 v[108:111], v[60:63], v[80:83], v[108:111]
v_mfma_f32_16x16x32_bf16 v[112:115], v[60:63], v[84:87], v[112:115]
v_mfma_f32_16x16x32_bf16 v[116:119], v[64:67], v[68:71], v[116:119]
v_mfma_f32_16x16x32_bf16 v[120:123], v[64:67], v[72:75], v[120:123]
v_mfma_f32_16x16x32_bf16 v[124:127], v[64:67], v[76:79], v[124:127]
v_mfma_f32_16x16x32_bf16 v[128:131], v[64:67], v[80:83], v[128:131]
v_mfma_f32_16x16x32_bf16 v[132:135], v[64:67], v[84:87], v[132:135]
s_add_u32 m0, s36, 110592
s_nop 0
buffer_load_dwordx4 v6, s[8:11], s40 offen lds
s_add_u32 m0, s36, 111616
s_nop 0
buffer_load_dwordx4 v7, s[8:11], s40 offen lds
s_add_u32 m0, s36, 112640
s_nop 0
buffer_load_dwordx4 v8, s[8:11], s40 offen lds
ds_read_b128 v[60:63], v91 offset:0
ds_read_b128 v[64:67], v91 offset:4096
ds_read_b128 v[68:71], v95 offset:0
ds_read_b128 v[72:75], v95 offset:4096
ds_read_b128 v[76:79], v95 offset:8192
ds_read_b128 v[80:83], v95 offset:12288
ds_read_b128 v[84:87], v95 offset:16384
s_waitcnt lgkmcnt(7)
v_mfma_f32_16x16x32_bf16 v[96:99], v[32:35], v[40:43], v[96:99]
v_mfma_f32_16x16x32_bf16 v[100:103], v[32:35], v[44:47], v[100:103]
v_mfma_f32_16x16x32_bf16 v[104:107], v[32:35], v[48:51], v[104:107]
v_mfma_f32_16x16x32_bf16 v[108:111], v[32:35], v[52:55], v[108:111]
v_mfma_f32_16x16x32_bf16 v[112:115], v[32:35], v[56:59], v[112:115]
v_mfma_f32_16x16x32_bf16 v[116:119], v[36:39], v[40:43], v[116:119]
v_mfma_f32_16x16x32_bf16 v[120:123], v[36:39], v[44:47], v[120:123]
v_mfma_f32_16x16x32_bf16 v[124:127], v[36:39], v[48:51], v[124:127]
v_mfma_f32_16x16x32_bf16 v[128:131], v[36:39], v[52:55], v[128:131]
v_mfma_f32_16x16x32_bf16 v[132:135], v[36:39], v[56:59], v[132:135]
s_add_u32 m0, s36, 113664
s_nop 0
buffer_load_dwordx4 v9, s[8:11], s40 offen lds
s_add_u32 m0, s37, 106496
s_nop 0
buffer_load_dwordx4 v10, s[12:15], s40 offen lds
s_add_u32 m0, s37, 107520
s_nop 0
buffer_load_dwordx4 v11, s[12:15], s40 offen lds
s_waitcnt lgkmcnt(0)
v_mfma_f32_16x16x32_bf16 v[96:99], v[60:63], v[68:71], v[96:99]
v_mfma_f32_16x16x32_bf16 v[100:103], v[60:63], v[72:75], v[100:103]
v_mfma_f32_16x16x32_bf16 v[104:107], v[60:63], v[76:79], v[104:107]
v_mfma_f32_16x16x32_bf16 v[108:111], v[60:63], v[80:83], v[108:111]
v_mfma_f32_16x16x32_bf16 v[112:115], v[60:63], v[84:87], v[112:115]
v_mfma_f32_16x16x32_bf16 v[116:119], v[64:67], v[68:71], v[116:119]
v_mfma_f32_16x16x32_bf16 v[120:123], v[64:67], v[72:75], v[120:123]
v_mfma_f32_16x16x32_bf16 v[124:127], v[64:67], v[76:79], v[124:127]
v_mfma_f32_16x16x32_bf16 v[128:131], v[64:67], v[80:83], v[128:131]
v_mfma_f32_16x16x32_bf16 v[132:135], v[64:67], v[84:87], v[132:135]
s_add_u32 m0, s37, 108544
s_nop 0
buffer_load_dwordx4 v12, s[12:15], s40 offen lds
s_add_u32 m0, s37, 109568
s_nop 0
buffer_load_dwordx4 v13, s[12:15], s40 offen lds
s_add_u32 m0, s37, 110592
s_nop 0
buffer_load_dwordx4 v14, s[12:15], s40 offen lds
s_waitcnt vmcnt(13)
s_barrier
v_add_u32 v88, 53248, v20
v_add_u32 v92, 53248, v24
v_add_u32 v89, 53248, v21
v_add_u32 v93, 53248, v25
v_add_u32 v90, 53248, v22
v_add_u32 v94, 53248, v26
v_add_u32 v91, 53248, v23
v_add_u32 v95, 53248, v27
s_mov_b32 s40, 768
ds_read_b128 v[32:35], v88 offset:0
ds_read_b128 v[36:39], v88 offset:4096
ds_read_b128 v[40:43], v92 offset:0
ds_read_b128 v[44:47], v92 offset:4096
ds_read_b128 v[48:51], v92 offset:8192
ds_read_b128 v[52:55], v92 offset:12288
ds_read_b128 v[56:59], v92 offset:16384
ds_read_b128 v[60:63], v89 offset:0
ds_read_b128 v[64:67], v89 offset:4096
ds_read_b128 v[68:71], v93 offset:0
ds_read_b128 v[72:75], v93 offset:4096
ds_read_b128 v[76:79], v93 offset:8192
ds_read_b128 v[80:83], v93 offset:12288
ds_read_b128 v[84:87], v93 offset:16384
s_waitcnt lgkmcnt(7)
v_mfma_f32_16x16x32_bf16 v[96:99], v[32:35], v[40:43], v[96:99]
v_mfma_f32_16x16x32_bf16 v[100:103], v[32:35], v[44:47], v[100:103]
v_mfma_f32_16x16x32_bf16 v[104:107], v[32:35], v[48:51], v[104:107]
v_mfma_f32_16x16x32_bf16 v[108:111], v[32:35], v[52:55], v[108:111]
v_mfma_f32_16x16x32_bf16 v[112:115], v[32:35], v[56:59], v[112:115]
v_mfma_f32_16x16x32_bf16 v[116:119], v[36:39], v[40:43], v[116:119]
v_mfma_f32_16x16x32_bf16 v[120:123], v[36:39], v[44:47], v[120:123]
v_mfma_f32_16x16x32_bf16 v[124:127], v[36:39], v[48:51], v[124:127]
v_mfma_f32_16x16x32_bf16 v[128:131], v[36:39], v[52:55], v[128:131]
v_mfma_f32_16x16x32_bf16 v[132:135], v[36:39], v[56:59], v[132:135]
s_add_u32 m0, s36, 0
s_nop 0
buffer_load_dwordx4 v2, s[8:11], s40 offen lds
s_add_u32 m0, s36, 1024
s_nop 0
buffer_load_dwordx4 v3, s[8:11], s40 offen lds
s_add_u32 m0, s36, 2048
s_nop 0
buffer_load_dwordx4 v4, s[8:11], s40 offen lds
s_add_u32 m0, s36, 3072
s_nop 0
buffer_load_dwordx4 v5, s[8:11], s40 offen lds
ds_read_b128 v[32:35], v90 offset:0
ds_read_b128 v[36:39], v90 offset:4096
ds_read_b128 v[40:43], v94 offset:0
ds_read_b128 v[44:47], v94 offset:4096
ds_read_b128 v[48:51], v94 offset:8192
ds_read_b128 v[52:55], v94 offset:12288
ds_read_b128 v[56:59], v94 offset:16384
s_waitcnt lgkmcnt(7)
v_mfma_f32_16x16x32_bf16 v[96:99], v[60:63], v[68:71], v[96:99]
v_mfma_f32_16x16x32_bf16 v[100:103], v[60:63], v[72:75], v[100:103]
v_mfma_f32_16x16x32_bf16 v[104:107], v[60:63], v[76:79], v[104:107]
v_mfma_f32_16x16x32_bf16 v[108:111], v[60:63], v[80:83], v[108:111]
v_mfma_f32_16x16x32_bf16 v[112:115], v[60:63], v[84:87], v[112:115]
v_mfma_f32_16x16x32_bf16 v[116:119], v[64:67], v[68:71], v[116:119]
v_mfma_f32_16x16x32_bf16 v[120:123], v[64:67], v[72:75], v[120:123]
v_mfma_f32_16x16x32_bf16 v[124:127], v[64:67], v[76:79], v[124:127]
v_mfma_f32_16x16x32_bf16 v[128:131], v[64:67], v[80:83], v[128:131]
v_mfma_f32_16x16x32_bf16 v[132:135], v[64:67], v[84:87], v[132:135]
s_add_u32 m0, s36, 4096
s_nop 0
buffer_load_dwordx4 v6, s[8:11], s40 offen lds
s_add_u32 m0, s36, 5120
s_nop 0
buffer_load_dwordx4 v7, s[8:11], s40 offen lds
s_add_u32 m0, s36, 6144
s_nop 0
buffer_load_dwordx4 v8, s[8:11], s40 offen lds
ds_read_b128 v[60:63], v91 offset:0
ds_read_b128 v[64:67], v91 offset:4096
ds_read_b128 v[68:71], v95 offset:0
ds_read_b128 v[72:75], v95 offset:4096
ds_read_b128 v[76:79], v95 offset:8192
ds_read_b128 v[80:83], v95 offset:12288
ds_read_b128 v[84:87], v95 offset:16384
s_waitcnt lgkmcnt(7)
v_mfma_f32_16x16x32_bf16 v[96:99], v[32:35], v[40:43], v[96:99]
v_mfma_f32_16x16x32_bf16 v[100:103], v[32:35], v[44:47], v[100:103]
v_mfma_f32_16x16x32_bf16 v[104:107], v[32:35], v[48:51], v[104:107]
v_mfma_f32_16x16x32_bf16 v[108:111], v[32:35], v[52:55], v[108:111]
v_mfma_f32_16x16x32_bf16 v[112:115], v[32:35], v[56:59], v[112:115]
v_mfma_f32_16x16x32_bf16 v[116:119], v[36:39], v[40:43], v[116:119]
v_mfma_f32_16x16x32_bf16 v[120:123], v[36:39], v[44:47], v[120:123]
v_mfma_f32_16x16x32_bf16 v[124:127], v[36:39], v[48:51], v[124:127]
v_mfma_f32_16x16x32_bf16 v[128:131], v[36:39], v[52:55], v[128:131]
v_mfma_f32_16x16x32_bf16 v[132:135], v[36:39], v[56:59], v[132:135]
s_add_u32 m0, s36, 7168
s_nop 0
buffer_load_dwordx4 v9, s[8:11], s40 offen lds
s_add_u32 m0, s37, 0
s_nop 0
buffer_load_dwordx4 v10, s[12:15], s40 offen lds
s_add_u32 m0, s37, 1024
s_nop 0
buffer_load_dwordx4 v11, s[12:15], s40 offen lds
s_waitcnt lgkmcnt(0)
v_mfma_f32_16x16x32_bf16 v[96:99], v[60:63], v[68:71], v[96:99]
v_mfma_f32_16x16x32_bf16 v[100:103], v[60:63], v[72:75], v[100:103]
v_mfma_f32_16x16x32_bf16 v[104:107], v[60:63], v[76:79], v[104:107]
v_mfma_f32_16x16x32_bf16 v[108:111], v[60:63], v[80:83], v[108:111]
v_mfma_f32_16x16x32_bf16 v[112:115], v[60:63], v[84:87], v[112:115]
v_mfma_f32_16x16x32_bf16 v[116:119], v[64:67], v[68:71], v[116:119]
v_mfma_f32_16x16x32_bf16 v[120:123], v[64:67], v[72:75], v[120:123]
v_mfma_f32_16x16x32_bf16 v[124:127], v[64:67], v[76:79], v[124:127]
v_mfma_f32_16x16x32_bf16 v[128:131], v[64:67], v[80:83], v[128:131]
v_mfma_f32_16x16x32_bf16 v[132:135], v[64:67], v[84:87], v[132:135]
s_add_u32 m0, s37, 2048
s_nop 0
buffer_load_dwordx4 v12, s[12:15], s40 offen lds
s_add_u32 m0, s37, 3072
s_nop 0
buffer_load_dwordx4 v13, s[12:15], s40 offen lds
s_add_u32 m0, s37, 4096
s_nop 0
buffer_load_dwordx4 v14, s[12:15], s40 offen lds
s_waitcnt vmcnt(13)
s_barrier
v_add_u32 v88, 106496, v20
v_add_u32 v92, 106496, v24
v_add_u32 v89, 106496, v21
v_add_u32 v93, 106496, v25
v_add_u32 v90, 106496, v22
v_add_u32 v94, 106496, v26
v_add_u32 v91, 106496, v23
v_add_u32 v95, 106496, v27
s_mov_b32 s40, 1024
ds_read_b128 v[32:35], v88 offset:0
ds_read_b128 v[36:39], v88 offset:4096
ds_read_b128 v[40:43], v92 offset:0
ds_read_b128 v[44:47], v92 offset:4096
ds_read_b128 v[48:51], v92 offset:8192
ds_read_b128 v[52:55], v92 offset:12288
ds_read_b128 v[56:59], v92 offset:16384
ds_read_b128 v[60:63], v89 offset:0
ds_read_b128 v[64:67], v89 offset:4096
ds_read_b128 v[68:71], v93 offset:0
ds_read_b128 v[72:75], v93 offset:4096
ds_read_b128 v[76:79], v93 offset:8192
ds_read_b128 v[80:83], v93 offset:12288
ds_read_b128 v[84:87], v93 offset:16384
s_waitcnt lgkmcnt(7)
v_mfma_f32_16x16x32_bf16 v[96:99], v[32:35], v[40:43], v[96:99]
v_mfma_f32_16x16x32_bf16 v[100:103], v[32:35], v[44:47], v[100:103]
v_mfma_f32_16x16x32_bf16 v[104:107], v[32:35], v[48:51], v[104:107]
v_mfma_f32_16x16x32_bf16 v[108:111], v[32:35], v[52:55], v[108:111]
v_mfma_f32_16x16x32_bf16 v[112:115], v[32:35], v[56:59], v[112:115]
v_mfma_f32_16x16x32_bf16 v[116:119], v[36:39], v[40:43], v[116:119]
v_mfma_f32_16x16x32_bf16 v[120:123], v[36:39], v[44:47], v[120:123]
v_mfma_f32_16x16x32_bf16 v[124:127], v[36:39], v[48:51], v[124:127]
v_mfma_f32_16x16x32_bf16 v[128:131], v[36:39], v[52:55], v[128:131]
v_mfma_f32_16x16x32_bf16 v[132:135], v[36:39], v[56:59], v[132:135]
s_add_u32 m0, s36, 53248
s_nop 0
buffer_load_dwordx4 v2, s[8:11], s40 offen lds
s_add_u32 m0, s36, 54272
s_nop 0
buffer_load_dwordx4 v3, s[8:11], s40 offen lds
s_add_u32 m0, s36, 55296
s_nop 0
buffer_load_dwordx4 v4, s[8:11], s40 offen lds
s_add_u32 m0, s36, 56320
s_nop 0
buffer_load_dwordx4 v5, s[8:11], s40 offen lds
ds_read_b128 v[32:35], v90 offset:0
ds_read_b128 v[36:39], v90 offset:4096
ds_read_b128 v[40:43], v94 offset:0
ds_read_b128 v[44:47], v94 offset:4096
ds_read_b128 v[48:51], v94 offset:8192
ds_read_b128 v[52:55], v94 offset:12288
ds_read_b128 v[56:59], v94 offset:16384
s_waitcnt lgkmcnt(7)
v_mfma_f32_16x16x32_bf16 v[96:99], v[60:63], v[68:71], v[96:99]
v_mfma_f32_16x16x32_bf16 v[100:103], v[60:63], v[72:75], v[100:103]
v_mfma_f32_16x16x32_bf16 v[104:107], v[60:63], v[76:79], v[104:107]
v_mfma_f32_16x16x32_bf16 v[108:111], v[60:63], v[80:83], v[108:111]
v_mfma_f32_16x16x32_bf16 v[112:115], v[60:63], v[84:87], v[112:115]
v_mfma_f32_16x16x32_bf16 v[116:119], v[64:67], v[68:71], v[116:119]
v_mfma_f32_16x16x32_bf16 v[120:123], v[64:67], v[72:75], v[120:123]
v_mfma_f32_16x16x32_bf16 v[124:127], v[64:67], v[76:79], v[124:127]
v_mfma_f32_16x16x32_bf16 v[128:131], v[64:67], v[80:83], v[128:131]
v_mfma_f32_16x16x32_bf16 v[132:135], v[64:67], v[84:87], v[132:135]
s_add_u32 m0, s36, 57344
s_nop 0
buffer_load_dwordx4 v6, s[8:11], s40 offen lds
s_add_u32 m0, s36, 58368
s_nop 0
buffer_load_dwordx4 v7, s[8:11], s40 offen lds
s_add_u32 m0, s36, 59392
s_nop 0
buffer_load_dwordx4 v8, s[8:11], s40 offen lds
ds_read_b128 v[60:63], v91 offset:0
ds_read_b128 v[64:67], v91 offset:4096
ds_read_b128 v[68:71], v95 offset:0
ds_read_b128 v[72:75], v95 offset:4096
ds_read_b128 v[76:79], v95 offset:8192
ds_read_b128 v[80:83], v95 offset:12288
ds_read_b128 v[84:87], v95 offset:16384
s_waitcnt lgkmcnt(7)
v_mfma_f32_16x16x32_bf16 v[96:99], v[32:35], v[40:43], v[96:99]
v_mfma_f32_16x16x32_bf16 v[100:103], v[32:35], v[44:47], v[100:103]
v_mfma_f32_16x16x32_bf16 v[104:107], v[32:35], v[48:51], v[104:107]
v_mfma_f32_16x16x32_bf16 v[108:111], v[32:35], v[52:55], v[108:111]
v_mfma_f32_16x16x32_bf16 v[112:115], v[32:35], v[56:59], v[112:115]
v_mfma_f32_16x16x32_bf16 v[116:119], v[36:39], v[40:43], v[116:119]
v_mfma_f32_16x16x32_bf16 v[120:123], v[36:39], v[44:47], v[120:123]
v_mfma_f32_16x16x32_bf16 v[124:127], v[36:39], v[48:51], v[124:127]
v_mfma_f32_16x16x32_bf16 v[128:131], v[36:39], v[52:55], v[128:131]
v_mfma_f32_16x16x32_bf16 v[132:135], v[36:39], v[56:59], v[132:135]
s_add_u32 m0, s36, 60416
s_nop 0
buffer_load_dwordx4 v9, s[8:11], s40 offen lds
s_add_u32 m0, s37, 53248
s_nop 0
buffer_load_dwordx4 v10, s[12:15], s40 offen lds
s_add_u32 m0, s37, 54272
s_nop 0
buffer_load_dwordx4 v11, s[12:15], s40 offen lds
s_waitcnt lgkmcnt(0)
v_mfma_f32_16x16x32_bf16 v[96:99], v[60:63], v[68:71], v[96:99]
v_mfma_f32_16x16x32_bf16 v[100:103], v[60:63], v[72:75], v[100:103]
v_mfma_f32_16x16x32_bf16 v[104:107], v[60:63], v[76:79], v[104:107]
v_mfma_f32_16x16x32_bf16 v[108:111], v[60:63], v[80:83], v[108:111]
v_mfma_f32_16x16x32_bf16 v[112:115], v[60:63], v[84:87], v[112:115]
v_mfma_f32_16x16x32_bf16 v[116:119], v[64:67], v[68:71], v[116:119]
v_mfma_f32_16x16x32_bf16 v[120:123], v[64:67], v[72:75], v[120:123]
v_mfma_f32_16x16x32_bf16 v[124:127], v[64:67], v[76:79], v[124:127]
v_mfma_f32_16x16x32_bf16 v[128:131], v[64:67], v[80:83], v[128:131]
v_mfma_f32_16x16x32_bf16 v[132:135], v[64:67], v[84:87], v[132:135]
s_add_u32 m0, s37, 55296
s_nop 0
buffer_load_dwordx4 v12, s[12:15], s40 offen lds
s_add_u32 m0, s37, 56320
s_nop 0
buffer_load_dwordx4 v13, s[12:15], s40 offen lds
s_add_u32 m0, s37, 57344
s_nop 0
buffer_load_dwordx4 v14, s[12:15], s40 offen lds
s_waitcnt vmcnt(13)
s_barrier
v_add_u32 v88, 0, v20
v_add_u32 v92, 0, v24
v_add_u32 v89, 0, v21
v_add_u32 v93, 0, v25
v_add_u32 v90, 0, v22
v_add_u32 v94, 0, v26
v_add_u32 v91, 0, v23
v_add_u32 v95, 0, v27
s_mov_b32 s40, 1280
ds_read_b128 v[32:35], v88 offset:0
ds_read_b128 v[36:39], v88 offset:4096
ds_read_b128 v[40:43], v92 offset:0
ds_read_b128 v[44:47], v92 offset:4096
ds_read_b128 v[48:51], v92 offset:8192
ds_read_b128 v[52:55], v92 offset:12288
ds_read_b128 v[56:59], v92 offset:16384
ds_read_b128 v[60:63], v89 offset:0
ds_read_b128 v[64:67], v89 offset:4096
ds_read_b128 v[68:71], v93 offset:0
ds_read_b128 v[72:75], v93 offset:4096
ds_read_b128 v[76:79], v93 offset:8192
ds_read_b128 v[80:83], v93 offset:12288
ds_read_b128 v[84:87], v93 offset:16384
s_waitcnt lgkmcnt(7)
v_mfma_f32_16x16x32_bf16 v[96:99], v[32:35], v[40:43], v[96:99]
v_mfma_f32_16x16x32_bf16 v[100:103], v[32:35], v[44:47], v[100:103]
v_mfma_f32_16x16x32_bf16 v[104:107], v[32:35], v[48:51], v[104:107]
v_mfma_f32_16x16x32_bf16 v[108:111], v[32:35], v[52:55], v[108:111]
v_mfma_f32_16x16x32_bf16 v[112:115], v[32:35], v[56:59], v[112:115]
v_mfma_f32_16x16x32_bf16 v[116:119], v[36:39], v[40:43], v[116:119]
v_mfma_f32_16x16x32_bf16 v[120:123], v[36:39], v[44:47], v[120:123]
v_mfma_f32_16x16x32_bf16 v[124:127], v[36:39], v[48:51], v[124:127]
v_mfma_f32_16x16x32_bf16 v[128:131], v[36:39], v[52:55], v[128:131]
v_mfma_f32_16x16x32_bf16 v[132:135], v[36:39], v[56:59], v[132:135]
s_add_u32 m0, s36, 106496
s_nop 0
buffer_load_dwordx4 v2, s[8:11], s40 offen lds
s_add_u32 m0, s36, 107520
s_nop 0
buffer_load_dwordx4 v3, s[8:11], s40 offen lds
s_add_u32 m0, s36, 108544
s_nop 0
buffer_load_dwordx4 v4, s[8:11], s40 offen lds
s_add_u32 m0, s36, 109568
s_nop 0
buffer_load_dwordx4 v5, s[8:11], s40 offen lds
ds_read_b128 v[32:35], v90 offset:0
ds_read_b128 v[36:39], v90 offset:4096
ds_read_b128 v[40:43], v94 offset:0
ds_read_b128 v[44:47], v94 offset:4096
ds_read_b128 v[48:51], v94 offset:8192
ds_read_b128 v[52:55], v94 offset:12288
ds_read_b128 v[56:59], v94 offset:16384
s_waitcnt lgkmcnt(7)
v_mfma_f32_16x16x32_bf16 v[96:99], v[60:63], v[68:71], v[96:99]
v_mfma_f32_16x16x32_bf16 v[100:103], v[60:63], v[72:75], v[100:103]
v_mfma_f32_16x16x32_bf16 v[104:107], v[60:63], v[76:79], v[104:107]
v_mfma_f32_16x16x32_bf16 v[108:111], v[60:63], v[80:83], v[108:111]
v_mfma_f32_16x16x32_bf16 v[112:115], v[60:63], v[84:87], v[112:115]
v_mfma_f32_16x16x32_bf16 v[116:119], v[64:67], v[68:71], v[116:119]
v_mfma_f32_16x16x32_bf16 v[120:123], v[64:67], v[72:75], v[120:123]
v_mfma_f32_16x16x32_bf16 v[124:127], v[64:67], v[76:79], v[124:127]
v_mfma_f32_16x16x32_bf16 v[128:131], v[64:67], v[80:83], v[128:131]
v_mfma_f32_16x16x32_bf16 v[132:135], v[64:67], v[84:87], v[132:135]
s_add_u32 m0, s36, 110592
s_nop 0
buffer_load_dwordx4 v6, s[8:11], s40 offen lds
s_add_u32 m0, s36, 111616
s_nop 0
buffer_load_dwordx4 v7, s[8:11], s40 offen lds
s_add_u32 m0, s36, 112640
s_nop 0
buffer_load_dwordx4 v8, s[8:11], s40 offen lds
ds_read_b128 v[60:63], v91 offset:0
ds_read_b128 v[64:67], v91 offset:4096
ds_read_b128 v[68:71], v95 offset:0
ds_read_b128 v[72:75], v95 offset:4096
ds_read_b128 v[76:79], v95 offset:8192
ds_read_b128 v[80:83], v95 offset:12288
ds_read_b128 v[84:87], v95 offset:16384
s_waitcnt lgkmcnt(7)
v_mfma_f32_16x16x32_bf16 v[96:99], v[32:35], v[40:43], v[96:99]
v_mfma_f32_16x16x32_bf16 v[100:103], v[32:35], v[44:47], v[100:103]
v_mfma_f32_16x16x32_bf16 v[104:107], v[32:35], v[48:51], v[104:107]
v_mfma_f32_16x16x32_bf16 v[108:111], v[32:35], v[52:55], v[108:111]
v_mfma_f32_16x16x32_bf16 v[112:115], v[32:35], v[56:59], v[112:115]
v_mfma_f32_16x16x32_bf16 v[116:119], v[36:39], v[40:43], v[116:119]
v_mfma_f32_16x16x32_bf16 v[120:123], v[36:39], v[44:47], v[120:123]
v_mfma_f32_16x16x32_bf16 v[124:127], v[36:39], v[48:51], v[124:127]
v_mfma_f32_16x16x32_bf16 v[128:131], v[36:39], v[52:55], v[128:131]
v_mfma_f32_16x16x32_bf16 v[132:135], v[36:39], v[56:59], v[132:135]
s_add_u32 m0, s36, 113664
s_nop 0
buffer_load_dwordx4 v9, s[8:11], s40 offen lds
s_add_u32 m0, s37, 106496
s_nop 0
buffer_load_dwordx4 v10, s[12:15], s40 offen lds
s_add_u32 m0, s37, 107520
s_nop 0
buffer_load_dwordx4 v11, s[12:15], s40 offen lds
s_waitcnt lgkmcnt(0)
v_mfma_f32_16x16x32_bf16 v[96:99], v[60:63], v[68:71], v[96:99]
v_mfma_f32_16x16x32_bf16 v[100:103], v[60:63], v[72:75], v[100:103]
v_mfma_f32_16x16x32_bf16 v[104:107], v[60:63], v[76:79], v[104:107]
v_mfma_f32_16x16x32_bf16 v[108:111], v[60:63], v[80:83], v[108:111]
v_mfma_f32_16x16x32_bf16 v[112:115], v[60:63], v[84:87], v[112:115]
v_mfma_f32_16x16x32_bf16 v[116:119], v[64:67], v[68:71], v[116:119]
v_mfma_f32_16x16x32_bf16 v[120:123], v[64:67], v[72:75], v[120:123]
v_mfma_f32_16x16x32_bf16 v[124:127], v[64:67], v[76:79], v[124:127]
v_mfma_f32_16x16x32_bf16 v[128:131], v[64:67], v[80:83], v[128:131]
v_mfma_f32_16x16x32_bf16 v[132:135], v[64:67], v[84:87], v[132:135]
s_add_u32 m0, s37, 108544
s_nop 0
buffer_load_dwordx4 v12, s[12:15], s40 offen lds
s_add_u32 m0, s37, 109568
s_nop 0
buffer_load_dwordx4 v13, s[12:15], s40 offen lds
s_add_u32 m0, s37, 110592
s_nop 0
buffer_load_dwordx4 v14, s[12:15], s40 offen lds
s_waitcnt vmcnt(13)
s_barrier
v_add_u32 v88, 53248, v20
v_add_u32 v92, 53248, v24
v_add_u32 v89, 53248, v21
v_add_u32 v93, 53248, v25
v_add_u32 v90, 53248, v22
v_add_u32 v94, 53248, v26
v_add_u32 v91, 53248, v23
v_add_u32 v95, 53248, v27
s_mov_b32 s40, 1536
ds_read_b128 v[32:35], v88 offset:0
ds_read_b128 v[36:39], v88 offset:4096
ds_read_b128 v[40:43], v92 offset:0
ds_read_b128 v[44:47], v92 offset:4096
ds_read_b128 v[48:51], v92 offset:8192
ds_read_b128 v[52:55], v92 offset:12288
ds_read_b128 v[56:59], v92 offset:16384
ds_read_b128 v[60:63], v89 offset:0
ds_read_b128 v[64:67], v89 offset:4096
ds_read_b128 v[68:71], v93 offset:0
ds_read_b128 v[72:75], v93 offset:4096
ds_read_b128 v[76:79], v93 offset:8192
ds_read_b128 v[80:83], v93 offset:12288
ds_read_b128 v[84:87], v93 offset:16384
s_waitcnt lgkmcnt(7)
v_mfma_f32_16x16x32_bf16 v[96:99], v[32:35], v[40:43], v[96:99]
v_mfma_f32_16x16x32_bf16 v[100:103], v[32:35], v[44:47], v[100:103]
v_mfma_f32_16x16x32_bf16 v[104:107], v[32:35], v[48:51], v[104:107]
v_mfma_f32_16x16x32_bf16 v[108:111], v[32:35], v[52:55], v[108:111]
v_mfma_f32_16x16x32_bf16 v[112:115], v[32:35], v[56:59], v[112:115]
v_mfma_f32_16x16x32_bf16 v[116:119], v[36:39], v[40:43], v[116:119]
v_mfma_f32_16x16x32_bf16 v[120:123], v[36:39], v[44:47], v[120:123]
v_mfma_f32_16x16x32_bf16 v[124:127], v[36:39], v[48:51], v[124:127]
v_mfma_f32_16x16x32_bf16 v[128:131], v[36:39], v[52:55], v[128:131]
v_mfma_f32_16x16x32_bf16 v[132:135], v[36:39], v[56:59], v[132:135]
s_add_u32 m0, s36, 0
s_nop 0
buffer_load_dwordx4 v2, s[8:11], s40 offen lds
s_add_u32 m0, s36, 1024
s_nop 0
buffer_load_dwordx4 v3, s[8:11], s40 offen lds
s_add_u32 m0, s36, 2048
s_nop 0
buffer_load_dwordx4 v4, s[8:11], s40 offen lds
s_add_u32 m0, s36, 3072
s_nop 0
buffer_load_dwordx4 v5, s[8:11], s40 offen lds
ds_read_b128 v[32:35], v90 offset:0
ds_read_b128 v[36:39], v90 offset:4096
ds_read_b128 v[40:43], v94 offset:0
ds_read_b128 v[44:47], v94 offset:4096
ds_read_b128 v[48:51], v94 offset:8192
ds_read_b128 v[52:55], v94 offset:12288
ds_read_b128 v[56:59], v94 offset:16384
s_waitcnt lgkmcnt(7)
v_mfma_f32_16x16x32_bf16 v[96:99], v[60:63], v[68:71], v[96:99]
v_mfma_f32_16x16x32_bf16 v[100:103], v[60:63], v[72:75], v[100:103]
v_mfma_f32_16x16x32_bf16 v[104:107], v[60:63], v[76:79], v[104:107]
v_mfma_f32_16x16x32_bf16 v[108:111], v[60:63], v[80:83], v[108:111]
v_mfma_f32_16x16x32_bf16 v[112:115], v[60:63], v[84:87], v[112:115]
v_mfma_f32_16x16x32_bf16 v[116:119], v[64:67], v[68:71], v[116:119]
v_mfma_f32_16x16x32_bf16 v[120:123], v[64:67], v[72:75], v[120:123]
v_mfma_f32_16x16x32_bf16 v[124:127], v[64:67], v[76:79], v[124:127]
v_mfma_f32_16x16x32_bf16 v[128:131], v[64:67], v[80:83], v[128:131]
v_mfma_f32_16x16x32_bf16 v[132:135], v[64:67], v[84:87], v[132:135]
s_add_u32 m0, s36, 4096
s_nop 0
buffer_load_dwordx4 v6, s[8:11], s40 offen lds
s_add_u32 m0, s36, 5120
s_nop 0
buffer_load_dwordx4 v7, s[8:11], s40 offen lds
s_add_u32 m0, s36, 6144
s_nop 0
buffer_load_dwordx4 v8, s[8:11], s40 offen lds
ds_read_b128 v[60:63], v91 offset:0
ds_read_b128 v[64:67], v91 offset:4096
ds_read_b128 v[68:71], v95 offset:0
ds_read_b128 v[72:75], v95 offset:4096
ds_read_b128 v[76:79], v95 offset:8192
ds_read_b128 v[80:83], v95 offset:12288
ds_read_b128 v[84:87], v95 offset:16384
s_waitcnt lgkmcnt(7)
v_mfma_f32_16x16x32_bf16 v[96:99], v[32:35], v[40:43], v[96:99]
v_mfma_f32_16x16x32_bf16 v[100:103], v[32:35], v[44:47], v[100:103]
v_mfma_f32_16x16x32_bf16 v[104:107], v[32:35], v[48:51], v[104:107]
v_mfma_f32_16x16x32_bf16 v[108:111], v[32:35], v[52:55], v[108:111]
v_mfma_f32_16x16x32_bf16 v[112:115], v[32:35], v[56:59], v[112:115]
v_mfma_f32_16x16x32_bf16 v[116:119], v[36:39], v[40:43], v[116:119]
v_mfma_f32_16x16x32_bf16 v[120:123], v[36:39], v[44:47], v[120:123]
v_mfma_f32_16x16x32_bf16 v[124:127], v[36:39], v[48:51], v[124:127]
v_mfma_f32_16x16x32_bf16 v[128:131], v[36:39], v[52:55], v[128:131]
v_mfma_f32_16x16x32_bf16 v[132:135], v[36:39], v[56:59], v[132:135]
s_add_u32 m0, s36, 7168
s_nop 0
buffer_load_dwordx4 v9, s[8:11], s40 offen lds
s_add_u32 m0, s37, 0
s_nop 0
buffer_load_dwordx4 v10, s[12:15], s40 offen lds
s_add_u32 m0, s37, 1024
s_nop 0
buffer_load_dwordx4 v11, s[12:15], s40 offen lds
s_waitcnt lgkmcnt(0)
v_mfma_f32_16x16x32_bf16 v[96:99], v[60:63], v[68:71], v[96:99]
v_mfma_f32_16x16x32_bf16 v[100:103], v[60:63], v[72:75], v[100:103]
v_mfma_f32_16x16x32_bf16 v[104:107], v[60:63], v[76:79], v[104:107]
v_mfma_f32_16x16x32_bf16 v[108:111], v[60:63], v[80:83], v[108:111]
v_mfma_f32_16x16x32_bf16 v[112:115], v[60:63], v[84:87], v[112:115]
v_mfma_f32_16x16x32_bf16 v[116:119], v[64:67], v[68:71], v[116:119]
v_mfma_f32_16x16x32_bf16 v[120:123], v[64:67], v[72:75], v[120:123]
v_mfma_f32_16x16x32_bf16 v[124:127], v[64:67], v[76:79], v[124:127]
v_mfma_f32_16x16x32_bf16 v[128:131], v[64:67], v[80:83], v[128:131]
v_mfma_f32_16x16x32_bf16 v[132:135], v[64:67], v[84:87], v[132:135]
s_add_u32 m0, s37, 2048
s_nop 0
buffer_load_dwordx4 v12, s[12:15], s40 offen lds
s_add_u32 m0, s37, 3072
s_nop 0
buffer_load_dwordx4 v13, s[12:15], s40 offen lds
s_add_u32 m0, s37, 4096
s_nop 0
buffer_load_dwordx4 v14, s[12:15], s40 offen lds
s_waitcnt vmcnt(13)
s_barrier
v_add_u32 v88, 106496, v20
v_add_u32 v92, 106496, v24
v_add_u32 v89, 106496, v21
v_add_u32 v93, 106496, v25
v_add_u32 v90, 106496, v22
v_add_u32 v94, 106496, v26
v_add_u32 v91, 106496, v23
v_add_u32 v95, 106496, v27
s_mov_b32 s40, 1792
ds_read_b128 v[32:35], v88 offset:0
ds_read_b128 v[36:39], v88 offset:4096
ds_read_b128 v[40:43], v92 offset:0
ds_read_b128 v[44:47], v92 offset:4096
ds_read_b128 v[48:51], v92 offset:8192
ds_read_b128 v[52:55], v92 offset:12288
ds_read_b128 v[56:59], v92 offset:16384
ds_read_b128 v[60:63], v89 offset:0
ds_read_b128 v[64:67], v89 offset:4096
ds_read_b128 v[68:71], v93 offset:0
ds_read_b128 v[72:75], v93 offset:4096
ds_read_b128 v[76:79], v93 offset:8192
ds_read_b128 v[80:83], v93 offset:12288
ds_read_b128 v[84:87], v93 offset:16384
s_waitcnt lgkmcnt(7)
v_mfma_f32_16x16x32_bf16 v[96:99], v[32:35], v[40:43], v[96:99]
v_mfma_f32_16x16x32_bf16 v[100:103], v[32:35], v[44:47], v[100:103]
v_mfma_f32_16x16x32_bf16 v[104:107], v[32:35], v[48:51], v[104:107]
v_mfma_f32_16x16x32_bf16 v[108:111], v[32:35], v[52:55], v[108:111]
v_mfma_f32_16x16x32_bf16 v[112:115], v[32:35], v[56:59], v[112:115]
v_mfma_f32_16x16x32_bf16 v[116:119], v[36:39], v[40:43], v[116:119]
v_mfma_f32_16x16x32_bf16 v[120:123], v[36:39], v[44:47], v[120:123]
v_mfma_f32_16x16x32_bf16 v[124:127], v[36:39], v[48:51], v[124:127]
v_mfma_f32_16x16x32_bf16 v[128:131], v[36:39], v[52:55], v[128:131]
v_mfma_f32_16x16x32_bf16 v[132:135], v[36:39], v[56:59], v[132:135]
s_add_u32 m0, s36, 53248
s_nop 0
buffer_load_dwordx4 v2, s[8:11], s40 offen lds
s_add_u32 m0, s36, 54272
s_nop 0
buffer_load_dwordx4 v3, s[8:11], s40 offen lds
s_add_u32 m0, s36, 55296
s_nop 0
buffer_load_dwordx4 v4, s[8:11], s40 offen lds
s_add_u32 m0, s36, 56320
s_nop 0
buffer_load_dwordx4 v5, s[8:11], s40 offen lds
ds_read_b128 v[32:35], v90 offset:0
ds_read_b128 v[36:39], v90 offset:4096
ds_read_b128 v[40:43], v94 offset:0
ds_read_b128 v[44:47], v94 offset:4096
ds_read_b128 v[48:51], v94 offset:8192
ds_read_b128 v[52:55], v94 offset:12288
ds_read_b128 v[56:59], v94 offset:16384
s_waitcnt lgkmcnt(7)
v_mfma_f32_16x16x32_bf16 v[96:99], v[60:63], v[68:71], v[96:99]
v_mfma_f32_16x16x32_bf16 v[100:103], v[60:63], v[72:75], v[100:103]
v_mfma_f32_16x16x32_bf16 v[104:107], v[60:63], v[76:79], v[104:107]
v_mfma_f32_16x16x32_bf16 v[108:111], v[60:63], v[80:83], v[108:111]
v_mfma_f32_16x16x32_bf16 v[112:115], v[60:63], v[84:87], v[112:115]
v_mfma_f32_16x16x32_bf16 v[116:119], v[64:67], v[68:71], v[116:119]
v_mfma_f32_16x16x32_bf16 v[120:123], v[64:67], v[72:75], v[120:123]
v_mfma_f32_16x16x32_bf16 v[124:127], v[64:67], v[76:79], v[124:127]
v_mfma_f32_16x16x32_bf16 v[128:131], v[64:67], v[80:83], v[128:131]
v_mfma_f32_16x16x32_bf16 v[132:135], v[64:67], v[84:87], v[132:135]
s_add_u32 m0, s36, 57344
s_nop 0
buffer_load_dwordx4 v6, s[8:11], s40 offen lds
s_add_u32 m0, s36, 58368
s_nop 0
buffer_load_dwordx4 v7, s[8:11], s40 offen lds
s_add_u32 m0, s36, 59392
s_nop 0
buffer_load_dwordx4 v8, s[8:11], s40 offen lds
ds_read_b128 v[60:63], v91 offset:0
ds_read_b128 v[64:67], v91 offset:4096
ds_read_b128 v[68:71], v95 offset:0
ds_read_b128 v[72:75], v95 offset:4096
ds_read_b128 v[76:79], v95 offset:8192
ds_read_b128 v[80:83], v95 offset:12288
ds_read_b128 v[84:87], v95 offset:16384
s_waitcnt lgkmcnt(7)
v_mfma_f32_16x16x32_bf16 v[96:99], v[32:35], v[40:43], v[96:99]
v_mfma_f32_16x16x32_bf16 v[100:103], v[32:35], v[44:47], v[100:103]
v_mfma_f32_16x16x32_bf16 v[104:107], v[32:35], v[48:51], v[104:107]
v_mfma_f32_16x16x32_bf16 v[108:111], v[32:35], v[52:55], v[108:111]
v_mfma_f32_16x16x32_bf16 v[112:115], v[32:35], v[56:59], v[112:115]
v_mfma_f32_16x16x32_bf16 v[116:119], v[36:39], v[40:43], v[116:119]
v_mfma_f32_16x16x32_bf16 v[120:123], v[36:39], v[44:47], v[120:123]
v_mfma_f32_16x16x32_bf16 v[124:127], v[36:39], v[48:51], v[124:127]
v_mfma_f32_16x16x32_bf16 v[128:131], v[36:39], v[52:55], v[128:131]
v_mfma_f32_16x16x32_bf16 v[132:135], v[36:39], v[56:59], v[132:135]
s_add_u32 m0, s36, 60416
s_nop 0
buffer_load_dwordx4 v9, s[8:11], s40 offen lds
s_add_u32 m0, s37, 53248
s_nop 0
buffer_load_dwordx4 v10, s[12:15], s40 offen lds
s_add_u32 m0, s37, 54272
s_nop 0
buffer_load_dwordx4 v11, s[12:15], s40 offen lds
s_waitcnt lgkmcnt(0)
v_mfma_f32_16x16x32_bf16 v[96:99], v[60:63], v[68:71], v[96:99]
v_mfma_f32_16x16x32_bf16 v[100:103], v[60:63], v[72:75], v[100:103]
v_mfma_f32_16x16x32_bf16 v[104:107], v[60:63], v[76:79], v[104:107]
v_mfma_f32_16x16x32_bf16 v[108:111], v[60:63], v[80:83], v[108:111]
v_mfma_f32_16x16x32_bf16 v[112:115], v[60:63], v[84:87], v[112:115]
v_mfma_f32_16x16x32_bf16 v[116:119], v[64:67], v[68:71], v[116:119]
v_mfma_f32_16x16x32_bf16 v[120:123], v[64:67], v[72:75], v[120:123]
v_mfma_f32_16x16x32_bf16 v[124:127], v[64:67], v[76:79], v[124:127]
v_mfma_f32_16x16x32_bf16 v[128:131], v[64:67], v[80:83], v[128:131]
v_mfma_f32_16x16x32_bf16 v[132:135], v[64:67], v[84:87], v[132:135]
s_add_u32 m0, s37, 55296
s_nop 0
buffer_load_dwordx4 v12, s[12:15], s40 offen lds
s_add_u32 m0, s37, 56320
s_nop 0
buffer_load_dwordx4 v13, s[12:15], s40 offen lds
s_add_u32 m0, s37, 57344
s_nop 0
buffer_load_dwordx4 v14, s[12:15], s40 offen lds
s_waitcnt vmcnt(13)
s_barrier
v_add_u32 v88, 0, v20
v_add_u32 v92, 0, v24
v_add_u32 v89, 0, v21
v_add_u32 v93, 0, v25
v_add_u32 v90, 0, v22
v_add_u32 v94, 0, v26
v_add_u32 v91, 0, v23
v_add_u32 v95, 0, v27
s_mov_b32 s40, 2048
ds_read_b128 v[32:35], v88 offset:0
ds_read_b128 v[36:39], v88 offset:4096
ds_read_b128 v[40:43], v92 offset:0
ds_read_b128 v[44:47], v92 offset:4096
ds_read_b128 v[48:51], v92 offset:8192
ds_read_b128 v[52:55], v92 offset:12288
ds_read_b128 v[56:59], v92 offset:16384
ds_read_b128 v[60:63], v89 offset:0
ds_read_b128 v[64:67], v89 offset:4096
ds_read_b128 v[68:71], v93 offset:0
ds_read_b128 v[72:75], v93 offset:4096
ds_read_b128 v[76:79], v93 offset:8192
ds_read_b128 v[80:83], v93 offset:12288
ds_read_b128 v[84:87], v93 offset:16384
s_waitcnt lgkmcnt(7)
v_mfma_f32_16x16x32_bf16 v[96:99], v[32:35], v[40:43], v[96:99]
v_mfma_f32_16x16x32_bf16 v[100:103], v[32:35], v[44:47], v[100:103]
v_mfma_f32_16x16x32_bf16 v[104:107], v[32:35], v[48:51], v[104:107]
v_mfma_f32_16x16x32_bf16 v[108:111], v[32:35], v[52:55], v[108:111]
v_mfma_f32_16x16x32_bf16 v[112:115], v[32:35], v[56:59], v[112:115]
v_mfma_f32_16x16x32_bf16 v[116:119], v[36:39], v[40:43], v[116:119]
v_mfma_f32_16x16x32_bf16 v[120:123], v[36:39], v[44:47], v[120:123]
v_mfma_f32_16x16x32_bf16 v[124:127], v[36:39], v[48:51], v[124:127]
v_mfma_f32_16x16x32_bf16 v[128:131], v[36:39], v[52:55], v[128:131]
v_mfma_f32_16x16x32_bf16 v[132:135], v[36:39], v[56:59], v[132:135]
s_add_u32 m0, s36, 106496
s_nop 0
buffer_load_dwordx4 v2, s[8:11], s40 offen lds
s_add_u32 m0, s36, 107520
s_nop 0
buffer_load_dwordx4 v3, s[8:11], s40 offen lds
s_add_u32 m0, s36, 108544
s_nop 0
buffer_load_dwordx4 v4, s[8:11], s40 offen lds
s_add_u32 m0, s36, 109568
s_nop 0
buffer_load_dwordx4 v5, s[8:11], s40 offen lds
ds_read_b128 v[32:35], v90 offset:0
ds_read_b128 v[36:39], v90 offset:4096
ds_read_b128 v[40:43], v94 offset:0
ds_read_b128 v[44:47], v94 offset:4096
ds_read_b128 v[48:51], v94 offset:8192
ds_read_b128 v[52:55], v94 offset:12288
ds_read_b128 v[56:59], v94 offset:16384
s_waitcnt lgkmcnt(7)
v_mfma_f32_16x16x32_bf16 v[96:99], v[60:63], v[68:71], v[96:99]
v_mfma_f32_16x16x32_bf16 v[100:103], v[60:63], v[72:75], v[100:103]
v_mfma_f32_16x16x32_bf16 v[104:107], v[60:63], v[76:79], v[104:107]
v_mfma_f32_16x16x32_bf16 v[108:111], v[60:63], v[80:83], v[108:111]
v_mfma_f32_16x16x32_bf16 v[112:115], v[60:63], v[84:87], v[112:115]
v_mfma_f32_16x16x32_bf16 v[116:119], v[64:67], v[68:71], v[116:119]
v_mfma_f32_16x16x32_bf16 v[120:123], v[64:67], v[72:75], v[120:123]
v_mfma_f32_16x16x32_bf16 v[124:127], v[64:67], v[76:79], v[124:127]
v_mfma_f32_16x16x32_bf16 v[128:131], v[64:67], v[80:83], v[128:131]
v_mfma_f32_16x16x32_bf16 v[132:135], v[64:67], v[84:87], v[132:135]
s_add_u32 m0, s36, 110592
s_nop 0
buffer_load_dwordx4 v6, s[8:11], s40 offen lds
s_add_u32 m0, s36, 111616
s_nop 0
buffer_load_dwordx4 v7, s[8:11], s40 offen lds
s_add_u32 m0, s36, 112640
s_nop 0
buffer_load_dwordx4 v8, s[8:11], s40 offen lds
ds_read_b128 v[60:63], v91 offset:0
ds_read_b128 v[64:67], v91 offset:4096
ds_read_b128 v[68:71], v95 offset:0
ds_read_b128 v[72:75], v95 offset:4096
ds_read_b128 v[76:79], v95 offset:8192
ds_read_b128 v[80:83], v95 offset:12288
ds_read_b128 v[84:87], v95 offset:16384
s_waitcnt lgkmcnt(7)
v_mfma_f32_16x16x32_bf16 v[96:99], v[32:35], v[40:43], v[96:99]
v_mfma_f32_16x16x32_bf16 v[100:103], v[32:35], v[44:47], v[100:103]
v_mfma_f32_16x16x32_bf16 v[104:107], v[32:35], v[48:51], v[104:107]
v_mfma_f32_16x16x32_bf16 v[108:111], v[32:35], v[52:55], v[108:111]
v_mfma_f32_16x16x32_bf16 v[112:115], v[32:35], v[56:59], v[112:115]
v_mfma_f32_16x16x32_bf16 v[116:119], v[36:39], v[40:43], v[116:119]
v_mfma_f32_16x16x32_bf16 v[120:123], v[36:39], v[44:47], v[120:123]
v_mfma_f32_16x16x32_bf16 v[124:127], v[36:39], v[48:51], v[124:127]
v_mfma_f32_16x16x32_bf16 v[128:131], v[36:39], v[52:55], v[128:131]
v_mfma_f32_16x16x32_bf16 v[132:135], v[36:39], v[56:59], v[132:135]
s_add_u32 m0, s36, 113664
s_nop 0
buffer_load_dwordx4 v9, s[8:11], s40 offen lds
s_add_u32 m0, s37, 106496
s_nop 0
buffer_load_dwordx4 v10, s[12:15], s40 offen lds
s_add_u32 m0, s37, 107520
s_nop 0
buffer_load_dwordx4 v11, s[12:15], s40 offen lds
s_waitcnt lgkmcnt(0)
v_mfma_f32_16x16x32_bf16 v[96:99], v[60:63], v[68:71], v[96:99]
v_mfma_f32_16x16x32_bf16 v[100:103], v[60:63], v[72:75], v[100:103]
v_mfma_f32_16x16x32_bf16 v[104:107], v[60:63], v[76:79], v[104:107]
v_mfma_f32_16x16x32_bf16 v[108:111], v[60:63], v[80:83], v[108:111]
v_mfma_f32_16x16x32_bf16 v[112:115], v[60:63], v[84:87], v[112:115]
v_mfma_f32_16x16x32_bf16 v[116:119], v[64:67], v[68:71], v[116:119]
v_mfma_f32_16x16x32_bf16 v[120:123], v[64:67], v[72:75], v[120:123]
v_mfma_f32_16x16x32_bf16 v[124:127], v[64:67], v[76:79], v[124:127]
v_mfma_f32_16x16x32_bf16 v[128:131], v[64:67], v[80:83], v[128:131]
v_mfma_f32_16x16x32_bf16 v[132:135], v[64:67], v[84:87], v[132:135]
s_add_u32 m0, s37, 108544
s_nop 0
buffer_load_dwordx4 v12, s[12:15], s40 offen lds
s_add_u32 m0, s37, 109568
s_nop 0
buffer_load_dwordx4 v13, s[12:15], s40 offen lds
s_add_u32 m0, s37, 110592
s_nop 0
buffer_load_dwordx4 v14, s[12:15], s40 offen lds
s_waitcnt vmcnt(13)
s_barrier
v_add_u32 v88, 53248, v20
v_add_u32 v92, 53248, v24
v_add_u32 v89, 53248, v21
v_add_u32 v93, 53248, v25
v_add_u32 v90, 53248, v22
v_add_u32 v94, 53248, v26
v_add_u32 v91, 53248, v23
v_add_u32 v95, 53248, v27
s_mov_b32 s40, 2304
ds_read_b128 v[32:35], v88 offset:0
ds_read_b128 v[36:39], v88 offset:4096
ds_read_b128 v[40:43], v92 offset:0
ds_read_b128 v[44:47], v92 offset:4096
ds_read_b128 v[48:51], v92 offset:8192
ds_read_b128 v[52:55], v92 offset:12288
ds_read_b128 v[56:59], v92 offset:16384
ds_read_b128 v[60:63], v89 offset:0
ds_read_b128 v[64:67], v89 offset:4096
ds_read_b128 v[68:71], v93 offset:0
ds_read_b128 v[72:75], v93 offset:4096
ds_read_b128 v[76:79], v93 offset:8192
ds_read_b128 v[80:83], v93 offset:12288
ds_read_b128 v[84:87], v93 offset:16384
s_waitcnt lgkmcnt(7)
v_mfma_f32_16x16x32_bf16 v[96:99], v[32:35], v[40:43], v[96:99]
v_mfma_f32_16x16x32_bf16 v[100:103], v[32:35], v[44:47], v[100:103]
v_mfma_f32_16x16x32_bf16 v[104:107], v[32:35], v[48:51], v[104:107]
v_mfma_f32_16x16x32_bf16 v[108:111], v[32:35], v[52:55], v[108:111]
v_mfma_f32_16x16x32_bf16 v[112:115], v[32:35], v[56:59], v[112:115]
v_mfma_f32_16x16x32_bf16 v[116:119], v[36:39], v[40:43], v[116:119]
v_mfma_f32_16x16x32_bf16 v[120:123], v[36:39], v[44:47], v[120:123]
v_mfma_f32_16x16x32_bf16 v[124:127], v[36:39], v[48:51], v[124:127]
v_mfma_f32_16x16x32_bf16 v[128:131], v[36:39], v[52:55], v[128:131]
v_mfma_f32_16x16x32_bf16 v[132:135], v[36:39], v[56:59], v[132:135]
s_add_u32 m0, s36, 0
s_nop 0
buffer_load_dwordx4 v2, s[8:11], s40 offen lds
s_add_u32 m0, s36, 1024
s_nop 0
buffer_load_dwordx4 v3, s[8:11], s40 offen lds
s_add_u32 m0, s36, 2048
s_nop 0
buffer_load_dwordx4 v4, s[8:11], s40 offen lds
s_add_u32 m0, s36, 3072
s_nop 0
buffer_load_dwordx4 v5, s[8:11], s40 offen lds
ds_read_b128 v[32:35], v90 offset:0
ds_read_b128 v[36:39], v90 offset:4096
ds_read_b128 v[40:43], v94 offset:0
ds_read_b128 v[44:47], v94 offset:4096
ds_read_b128 v[48:51], v94 offset:8192
ds_read_b128 v[52:55], v94 offset:12288
ds_read_b128 v[56:59], v94 offset:16384
s_waitcnt lgkmcnt(7)
v_mfma_f32_16x16x32_bf16 v[96:99], v[60:63], v[68:71], v[96:99]
v_mfma_f32_16x16x32_bf16 v[100:103], v[60:63], v[72:75], v[100:103]
v_mfma_f32_16x16x32_bf16 v[104:107], v[60:63], v[76:79], v[104:107]
v_mfma_f32_16x16x32_bf16 v[108:111], v[60:63], v[80:83], v[108:111]
v_mfma_f32_16x16x32_bf16 v[112:115], v[60:63], v[84:87], v[112:115]
v_mfma_f32_16x16x32_bf16 v[116:119], v[64:67], v[68:71], v[116:119]
v_mfma_f32_16x16x32_bf16 v[120:123], v[64:67], v[72:75], v[120:123]
v_mfma_f32_16x16x32_bf16 v[124:127], v[64:67], v[76:79], v[124:127]
v_mfma_f32_16x16x32_bf16 v[128:131], v[64:67], v[80:83], v[128:131]
v_mfma_f32_16x16x32_bf16 v[132:135], v[64:67], v[84:87], v[132:135]
s_add_u32 m0, s36, 4096
s_nop 0
buffer_load_dwordx4 v6, s[8:11], s40 offen lds
s_add_u32 m0, s36, 5120
s_nop 0
buffer_load_dwordx4 v7, s[8:11], s40 offen lds
s_add_u32 m0, s36, 6144
s_nop 0
buffer_load_dwordx4 v8, s[8:11], s40 offen lds
ds_read_b128 v[60:63], v91 offset:0
ds_read_b128 v[64:67], v91 offset:4096
ds_read_b128 v[68:71], v95 offset:0
ds_read_b128 v[72:75], v95 offset:4096
ds_read_b128 v[76:79], v95 offset:8192
ds_read_b128 v[80:83], v95 offset:12288
ds_read_b128 v[84:87], v95 offset:16384
s_waitcnt lgkmcnt(7)
v_mfma_f32_16x16x32_bf16 v[96:99], v[32:35], v[40:43], v[96:99]
v_mfma_f32_16x16x32_bf16 v[100:103], v[32:35], v[44:47], v[100:103]
v_mfma_f32_16x16x32_bf16 v[104:107], v[32:35], v[48:51], v[104:107]
v_mfma_f32_16x16x32_bf16 v[108:111], v[32:35], v[52:55], v[108:111]
v_mfma_f32_16x16x32_bf16 v[112:115], v[32:35], v[56:59], v[112:115]
v_mfma_f32_16x16x32_bf16 v[116:119], v[36:39], v[40:43], v[116:119]
v_mfma_f32_16x16x32_bf16 v[120:123], v[36:39], v[44:47], v[120:123]
v_mfma_f32_16x16x32_bf16 v[124:127], v[36:39], v[48:51], v[124:127]
v_mfma_f32_16x16x32_bf16 v[128:131], v[36:39], v[52:55], v[128:131]
v_mfma_f32_16x16x32_bf16 v[132:135], v[36:39], v[56:59], v[132:135]
s_add_u32 m0, s36, 7168
s_nop 0
buffer_load_dwordx4 v9, s[8:11], s40 offen lds
s_add_u32 m0, s37, 0
s_nop 0
buffer_load_dwordx4 v10, s[12:15], s40 offen lds
s_add_u32 m0, s37, 1024
s_nop 0
buffer_load_dwordx4 v11, s[12:15], s40 offen lds
s_waitcnt lgkmcnt(0)
v_mfma_f32_16x16x32_bf16 v[96:99], v[60:63], v[68:71], v[96:99]
v_mfma_f32_16x16x32_bf16 v[100:103], v[60:63], v[72:75], v[100:103]
v_mfma_f32_16x16x32_bf16 v[104:107], v[60:63], v[76:79], v[104:107]
v_mfma_f32_16x16x32_bf16 v[108:111], v[60:63], v[80:83], v[108:111]
v_mfma_f32_16x16x32_bf16 v[112:115], v[60:63], v[84:87], v[112:115]
v_mfma_f32_16x16x32_bf16 v[116:119], v[64:67], v[68:71], v[116:119]
v_mfma_f32_16x16x32_bf16 v[120:123], v[64:67], v[72:75], v[120:123]
v_mfma_f32_16x16x32_bf16 v[124:127], v[64:67], v[76:79], v[124:127]
v_mfma_f32_16x16x32_bf16 v[128:131], v[64:67], v[80:83], v[128:131]
v_mfma_f32_16x16x32_bf16 v[132:135], v[64:67], v[84:87], v[132:135]
s_add_u32 m0, s37, 2048
s_nop 0
buffer_load_dwordx4 v12, s[12:15], s40 offen lds
s_add_u32 m0, s37, 3072
s_nop 0
buffer_load_dwordx4 v13, s[12:15], s40 offen lds
s_add_u32 m0, s37, 4096
s_nop 0
buffer_load_dwordx4 v14, s[12:15], s40 offen lds
s_waitcnt vmcnt(13)
s_barrier
v_add_u32 v88, 106496, v20
v_add_u32 v92, 106496, v24
v_add_u32 v89, 106496, v21
v_add_u32 v93, 106496, v25
v_add_u32 v90, 106496, v22
v_add_u32 v94, 106496, v26
v_add_u32 v91, 106496, v23
v_add_u32 v95, 106496, v27
s_mov_b32 s40, 2560
ds_read_b128 v[32:35], v88 offset:0
ds_read_b128 v[36:39], v88 offset:4096
ds_read_b128 v[40:43], v92 offset:0
ds_read_b128 v[44:47], v92 offset:4096
ds_read_b128 v[48:51], v92 offset:8192
ds_read_b128 v[52:55], v92 offset:12288
ds_read_b128 v[56:59], v92 offset:16384
ds_read_b128 v[60:63], v89 offset:0
ds_read_b128 v[64:67], v89 offset:4096
ds_read_b128 v[68:71], v93 offset:0
ds_read_b128 v[72:75], v93 offset:4096
ds_read_b128 v[76:79], v93 offset:8192
ds_read_b128 v[80:83], v93 offset:12288
ds_read_b128 v[84:87], v93 offset:16384
s_waitcnt lgkmcnt(7)
v_mfma_f32_16x16x32_bf16 v[96:99], v[32:35], v[40:43], v[96:99]
v_mfma_f32_16x16x32_bf16 v[100:103], v[32:35], v[44:47], v[100:103]
v_mfma_f32_16x16x32_bf16 v[104:107], v[32:35], v[48:51], v[104:107]
v_mfma_f32_16x16x32_bf16 v[108:111], v[32:35], v[52:55], v[108:111]
v_mfma_f32_16x16x32_bf16 v[112:115], v[32:35], v[56:59], v[112:115]
v_mfma_f32_16x16x32_bf16 v[116:119], v[36:39], v[40:43], v[116:119]
v_mfma_f32_16x16x32_bf16 v[120:123], v[36:39], v[44:47], v[120:123]
v_mfma_f32_16x16x32_bf16 v[124:127], v[36:39], v[48:51], v[124:127]
v_mfma_f32_16x16x32_bf16 v[128:131], v[36:39], v[52:55], v[128:131]
v_mfma_f32_16x16x32_bf16 v[132:135], v[36:39], v[56:59], v[132:135]
s_add_u32 m0, s36, 53248
s_nop 0
buffer_load_dwordx4 v2, s[8:11], s40 offen lds
s_add_u32 m0, s36, 54272
s_nop 0
buffer_load_dwordx4 v3, s[8:11], s40 offen lds
s_add_u32 m0, s36, 55296
s_nop 0
buffer_load_dwordx4 v4, s[8:11], s40 offen lds
s_add_u32 m0, s36, 56320
s_nop 0
buffer_load_dwordx4 v5, s[8:11], s40 offen lds
ds_read_b128 v[32:35], v90 offset:0
ds_read_b128 v[36:39], v90 offset:4096
ds_read_b128 v[40:43], v94 offset:0
ds_read_b128 v[44:47], v94 offset:4096
ds_read_b128 v[48:51], v94 offset:8192
ds_read_b128 v[52:55], v94 offset:12288
ds_read_b128 v[56:59], v94 offset:16384
s_waitcnt lgkmcnt(7)
v_mfma_f32_16x16x32_bf16 v[96:99], v[60:63], v[68:71], v[96:99]
v_mfma_f32_16x16x32_bf16 v[100:103], v[60:63], v[72:75], v[100:103]
v_mfma_f32_16x16x32_bf16 v[104:107], v[60:63], v[76:79], v[104:107]
v_mfma_f32_16x16x32_bf16 v[108:111], v[60:63], v[80:83], v[108:111]
v_mfma_f32_16x16x32_bf16 v[112:115], v[60:63], v[84:87], v[112:115]
v_mfma_f32_16x16x32_bf16 v[116:119], v[64:67], v[68:71], v[116:119]
v_mfma_f32_16x16x32_bf16 v[120:123], v[64:67], v[72:75], v[120:123]
v_mfma_f32_16x16x32_bf16 v[124:127], v[64:67], v[76:79], v[124:127]
v_mfma_f32_16x16x32_bf16 v[128:131], v[64:67], v[80:83], v[128:131]
v_mfma_f32_16x16x32_bf16 v[132:135], v[64:67], v[84:87], v[132:135]
s_add_u32 m0, s36, 57344
s_nop 0
buffer_load_dwordx4 v6, s[8:11], s40 offen lds
s_add_u32 m0, s36, 58368
s_nop 0
buffer_load_dwordx4 v7, s[8:11], s40 offen lds
s_add_u32 m0, s36, 59392
s_nop 0
buffer_load_dwordx4 v8, s[8:11], s40 offen lds
ds_read_b128 v[60:63], v91 offset:0
ds_read_b128 v[64:67], v91 offset:4096
ds_read_b128 v[68:71], v95 offset:0
ds_read_b128 v[72:75], v95 offset:4096
ds_read_b128 v[76:79], v95 offset:8192
ds_read_b128 v[80:83], v95 offset:12288
ds_read_b128 v[84:87], v95 offset:16384
s_waitcnt lgkmcnt(7)
v_mfma_f32_16x16x32_bf16 v[96:99], v[32:35], v[40:43], v[96:99]
v_mfma_f32_16x16x32_bf16 v[100:103], v[32:35], v[44:47], v[100:103]
v_mfma_f32_16x16x32_bf16 v[104:107], v[32:35], v[48:51], v[104:107]
v_mfma_f32_16x16x32_bf16 v[108:111], v[32:35], v[52:55], v[108:111]
v_mfma_f32_16x16x32_bf16 v[112:115], v[32:35], v[56:59], v[112:115]
v_mfma_f32_16x16x32_bf16 v[116:119], v[36:39], v[40:43], v[116:119]
v_mfma_f32_16x16x32_bf16 v[120:123], v[36:39], v[44:47], v[120:123]
v_mfma_f32_16x16x32_bf16 v[124:127], v[36:39], v[48:51], v[124:127]
v_mfma_f32_16x16x32_bf16 v[128:131], v[36:39], v[52:55], v[128:131]
v_mfma_f32_16x16x32_bf16 v[132:135], v[36:39], v[56:59], v[132:135]
s_add_u32 m0, s36, 60416
s_nop 0
buffer_load_dwordx4 v9, s[8:11], s40 offen lds
s_add_u32 m0, s37, 53248
s_nop 0
buffer_load_dwordx4 v10, s[12:15], s40 offen lds
s_add_u32 m0, s37, 54272
s_nop 0
buffer_load_dwordx4 v11, s[12:15], s40 offen lds
s_waitcnt lgkmcnt(0)
v_mfma_f32_16x16x32_bf16 v[96:99], v[60:63], v[68:71], v[96:99]
v_mfma_f32_16x16x32_bf16 v[100:103], v[60:63], v[72:75], v[100:103]
v_mfma_f32_16x16x32_bf16 v[104:107], v[60:63], v[76:79], v[104:107]
v_mfma_f32_16x16x32_bf16 v[108:111], v[60:63], v[80:83], v[108:111]
v_mfma_f32_16x16x32_bf16 v[112:115], v[60:63], v[84:87], v[112:115]
v_mfma_f32_16x16x32_bf16 v[116:119], v[64:67], v[68:71], v[116:119]
v_mfma_f32_16x16x32_bf16 v[120:123], v[64:67], v[72:75], v[120:123]
v_mfma_f32_16x16x32_bf16 v[124:127], v[64:67], v[76:79], v[124:127]
v_mfma_f32_16x16x32_bf16 v[128:131], v[64:67], v[80:83], v[128:131]
v_mfma_f32_16x16x32_bf16 v[132:135], v[64:67], v[84:87], v[132:135]
s_add_u32 m0, s37, 55296
s_nop 0
buffer_load_dwordx4 v12, s[12:15], s40 offen lds
s_add_u32 m0, s37, 56320
s_nop 0
buffer_load_dwordx4 v13, s[12:15], s40 offen lds
s_add_u32 m0, s37, 57344
s_nop 0
buffer_load_dwordx4 v14, s[12:15], s40 offen lds
s_waitcnt vmcnt(13)
s_barrier
v_add_u32 v88, 0, v20
v_add_u32 v92, 0, v24
v_add_u32 v89, 0, v21
v_add_u32 v93, 0, v25
v_add_u32 v90, 0, v22
v_add_u32 v94, 0, v26
v_add_u32 v91, 0, v23
v_add_u32 v95, 0, v27
s_mov_b32 s40, 2816
ds_read_b128 v[32:35], v88 offset:0
ds_read_b128 v[36:39], v88 offset:4096
ds_read_b128 v[40:43], v92 offset:0
ds_read_b128 v[44:47], v92 offset:4096
ds_read_b128 v[48:51], v92 offset:8192
ds_read_b128 v[52:55], v92 offset:12288
ds_read_b128 v[56:59], v92 offset:16384
ds_read_b128 v[60:63], v89 offset:0
ds_read_b128 v[64:67], v89 offset:4096
ds_read_b128 v[68:71], v93 offset:0
ds_read_b128 v[72:75], v93 offset:4096
ds_read_b128 v[76:79], v93 offset:8192
ds_read_b128 v[80:83], v93 offset:12288
ds_read_b128 v[84:87], v93 offset:16384
s_waitcnt lgkmcnt(7)
v_mfma_f32_16x16x32_bf16 v[96:99], v[32:35], v[40:43], v[96:99]
v_mfma_f32_16x16x32_bf16 v[100:103], v[32:35], v[44:47], v[100:103]
v_mfma_f32_16x16x32_bf16 v[104:107], v[32:35], v[48:51], v[104:107]
v_mfma_f32_16x16x32_bf16 v[108:111], v[32:35], v[52:55], v[108:111]
v_mfma_f32_16x16x32_bf16 v[112:115], v[32:35], v[56:59], v[112:115]
v_mfma_f32_16x16x32_bf16 v[116:119], v[36:39], v[40:43], v[116:119]
v_mfma_f32_16x16x32_bf16 v[120:123], v[36:39], v[44:47], v[120:123]
v_mfma_f32_16x16x32_bf16 v[124:127], v[36:39], v[48:51], v[124:127]
v_mfma_f32_16x16x32_bf16 v[128:131], v[36:39], v[52:55], v[128:131]
v_mfma_f32_16x16x32_bf16 v[132:135], v[36:39], v[56:59], v[132:135]
s_add_u32 m0, s36, 106496
s_nop 0
buffer_load_dwordx4 v2, s[8:11], s40 offen lds
s_add_u32 m0, s36, 107520
s_nop 0
buffer_load_dwordx4 v3, s[8:11], s40 offen lds
s_add_u32 m0, s36, 108544
s_nop 0
buffer_load_dwordx4 v4, s[8:11], s40 offen lds
s_add_u32 m0, s36, 109568
s_nop 0
buffer_load_dwordx4 v5, s[8:11], s40 offen lds
ds_read_b128 v[32:35], v90 offset:0
ds_read_b128 v[36:39], v90 offset:4096
ds_read_b128 v[40:43], v94 offset:0
ds_read_b128 v[44:47], v94 offset:4096
ds_read_b128 v[48:51], v94 offset:8192
ds_read_b128 v[52:55], v94 offset:12288
ds_read_b128 v[56:59], v94 offset:16384
s_waitcnt lgkmcnt(7)
v_mfma_f32_16x16x32_bf16 v[96:99], v[60:63], v[68:71], v[96:99]
v_mfma_f32_16x16x32_bf16 v[100:103], v[60:63], v[72:75], v[100:103]
v_mfma_f32_16x16x32_bf16 v[104:107], v[60:63], v[76:79], v[104:107]
v_mfma_f32_16x16x32_bf16 v[108:111], v[60:63], v[80:83], v[108:111]
v_mfma_f32_16x16x32_bf16 v[112:115], v[60:63], v[84:87], v[112:115]
v_mfma_f32_16x16x32_bf16 v[116:119], v[64:67], v[68:71], v[116:119]
v_mfma_f32_16x16x32_bf16 v[120:123], v[64:67], v[72:75], v[120:123]
v_mfma_f32_16x16x32_bf16 v[124:127], v[64:67], v[76:79], v[124:127]
v_mfma_f32_16x16x32_bf16 v[128:131], v[64:67], v[80:83], v[128:131]
v_mfma_f32_16x16x32_bf16 v[132:135], v[64:67], v[84:87], v[132:135]
s_add_u32 m0, s36, 110592
s_nop 0
buffer_load_dwordx4 v6, s[8:11], s40 offen lds
s_add_u32 m0, s36, 111616
s_nop 0
buffer_load_dwordx4 v7, s[8:11], s40 offen lds
s_add_u32 m0, s36, 112640
s_nop 0
buffer_load_dwordx4 v8, s[8:11], s40 offen lds
ds_read_b128 v[60:63], v91 offset:0
ds_read_b128 v[64:67], v91 offset:4096
ds_read_b128 v[68:71], v95 offset:0
ds_read_b128 v[72:75], v95 offset:4096
ds_read_b128 v[76:79], v95 offset:8192
ds_read_b128 v[80:83], v95 offset:12288
ds_read_b128 v[84:87], v95 offset:16384
s_waitcnt lgkmcnt(7)
v_mfma_f32_16x16x32_bf16 v[96:99], v[32:35], v[40:43], v[96:99]
v_mfma_f32_16x16x32_bf16 v[100:103], v[32:35], v[44:47], v[100:103]
v_mfma_f32_16x16x32_bf16 v[104:107], v[32:35], v[48:51], v[104:107]
v_mfma_f32_16x16x32_bf16 v[108:111], v[32:35], v[52:55], v[108:111]
v_mfma_f32_16x16x32_bf16 v[112:115], v[32:35], v[56:59], v[112:115]
v_mfma_f32_16x16x32_bf16 v[116:119], v[36:39], v[40:43], v[116:119]
v_mfma_f32_16x16x32_bf16 v[120:123], v[36:39], v[44:47], v[120:123]
v_mfma_f32_16x16x32_bf16 v[124:127], v[36:39], v[48:51], v[124:127]
v_mfma_f32_16x16x32_bf16 v[128:131], v[36:39], v[52:55], v[128:131]
v_mfma_f32_16x16x32_bf16 v[132:135], v[36:39], v[56:59], v[132:135]
s_add_u32 m0, s36, 113664
s_nop 0
buffer_load_dwordx4 v9, s[8:11], s40 offen lds
s_add_u32 m0, s37, 106496
s_nop 0
buffer_load_dwordx4 v10, s[12:15], s40 offen lds
s_add_u32 m0, s37, 107520
s_nop 0
buffer_load_dwordx4 v11, s[12:15], s40 offen lds
s_waitcnt lgkmcnt(0)
v_mfma_f32_16x16x32_bf16 v[96:99], v[60:63], v[68:71], v[96:99]
v_mfma_f32_16x16x32_bf16 v[100:103], v[60:63], v[72:75], v[100:103]
v_mfma_f32_16x16x32_bf16 v[104:107], v[60:63], v[76:79], v[104:107]
v_mfma_f32_16x16x32_bf16 v[108:111], v[60:63], v[80:83], v[108:111]
v_mfma_f32_16x16x32_bf16 v[112:115], v[60:63], v[84:87], v[112:115]
v_mfma_f32_16x16x32_bf16 v[116:119], v[64:67], v[68:71], v[116:119]
v_mfma_f32_16x16x32_bf16 v[120:123], v[64:67], v[72:75], v[120:123]
v_mfma_f32_16x16x32_bf16 v[124:127], v[64:67], v[76:79], v[124:127]
v_mfma_f32_16x16x32_bf16 v[128:131], v[64:67], v[80:83], v[128:131]
v_mfma_f32_16x16x32_bf16 v[132:135], v[64:67], v[84:87], v[132:135]
s_add_u32 m0, s37, 108544
s_nop 0
buffer_load_dwordx4 v12, s[12:15], s40 offen lds
s_add_u32 m0, s37, 109568
s_nop 0
buffer_load_dwordx4 v13, s[12:15], s40 offen lds
s_add_u32 m0, s37, 110592
s_nop 0
buffer_load_dwordx4 v14, s[12:15], s40 offen lds
s_waitcnt vmcnt(13)
s_barrier
v_add_u32 v88, 53248, v20
v_add_u32 v92, 53248, v24
v_add_u32 v89, 53248, v21
v_add_u32 v93, 53248, v25
v_add_u32 v90, 53248, v22
v_add_u32 v94, 53248, v26
v_add_u32 v91, 53248, v23
v_add_u32 v95, 53248, v27
s_mov_b32 s40, 3072
ds_read_b128 v[32:35], v88 offset:0
ds_read_b128 v[36:39], v88 offset:4096
ds_read_b128 v[40:43], v92 offset:0
ds_read_b128 v[44:47], v92 offset:4096
ds_read_b128 v[48:51], v92 offset:8192
ds_read_b128 v[52:55], v92 offset:12288
ds_read_b128 v[56:59], v92 offset:16384
ds_read_b128 v[60:63], v89 offset:0
ds_read_b128 v[64:67], v89 offset:4096
ds_read_b128 v[68:71], v93 offset:0
ds_read_b128 v[72:75], v93 offset:4096
ds_read_b128 v[76:79], v93 offset:8192
ds_read_b128 v[80:83], v93 offset:12288
ds_read_b128 v[84:87], v93 offset:16384
s_waitcnt lgkmcnt(7)
v_mfma_f32_16x16x32_bf16 v[96:99], v[32:35], v[40:43], v[96:99]
v_mfma_f32_16x16x32_bf16 v[100:103], v[32:35], v[44:47], v[100:103]
v_mfma_f32_16x16x32_bf16 v[104:107], v[32:35], v[48:51], v[104:107]
v_mfma_f32_16x16x32_bf16 v[108:111], v[32:35], v[52:55], v[108:111]
v_mfma_f32_16x16x32_bf16 v[112:115], v[32:35], v[56:59], v[112:115]
v_mfma_f32_16x16x32_bf16 v[116:119], v[36:39], v[40:43], v[116:119]
v_mfma_f32_16x16x32_bf16 v[120:123], v[36:39], v[44:47], v[120:123]
v_mfma_f32_16x16x32_bf16 v[124:127], v[36:39], v[48:51], v[124:127]
v_mfma_f32_16x16x32_bf16 v[128:131], v[36:39], v[52:55], v[128:131]
v_mfma_f32_16x16x32_bf16 v[132:135], v[36:39], v[56:59], v[132:135]
s_add_u32 m0, s36, 0
s_nop 0
buffer_load_dwordx4 v2, s[8:11], s40 offen lds
s_add_u32 m0, s36, 1024
s_nop 0
buffer_load_dwordx4 v3, s[8:11], s40 offen lds
s_add_u32 m0, s36, 2048
s_nop 0
buffer_load_dwordx4 v4, s[8:11], s40 offen lds
s_add_u32 m0, s36, 3072
s_nop 0
buffer_load_dwordx4 v5, s[8:11], s40 offen lds
ds_read_b128 v[32:35], v90 offset:0
ds_read_b128 v[36:39], v90 offset:4096
ds_read_b128 v[40:43], v94 offset:0
ds_read_b128 v[44:47], v94 offset:4096
ds_read_b128 v[48:51], v94 offset:8192
ds_read_b128 v[52:55], v94 offset:12288
ds_read_b128 v[56:59], v94 offset:16384
s_waitcnt lgkmcnt(7)
v_mfma_f32_16x16x32_bf16 v[96:99], v[60:63], v[68:71], v[96:99]
v_mfma_f32_16x16x32_bf16 v[100:103], v[60:63], v[72:75], v[100:103]
v_mfma_f32_16x16x32_bf16 v[104:107], v[60:63], v[76:79], v[104:107]
v_mfma_f32_16x16x32_bf16 v[108:111], v[60:63], v[80:83], v[108:111]
v_mfma_f32_16x16x32_bf16 v[112:115], v[60:63], v[84:87], v[112:115]
v_mfma_f32_16x16x32_bf16 v[116:119], v[64:67], v[68:71], v[116:119]
v_mfma_f32_16x16x32_bf16 v[120:123], v[64:67], v[72:75], v[120:123]
v_mfma_f32_16x16x32_bf16 v[124:127], v[64:67], v[76:79], v[124:127]
v_mfma_f32_16x16x32_bf16 v[128:131], v[64:67], v[80:83], v[128:131]
v_mfma_f32_16x16x32_bf16 v[132:135], v[64:67], v[84:87], v[132:135]
s_add_u32 m0, s36, 4096
s_nop 0
buffer_load_dwordx4 v6, s[8:11], s40 offen lds
s_add_u32 m0, s36, 5120
s_nop 0
buffer_load_dwordx4 v7, s[8:11], s40 offen lds
s_add_u32 m0, s36, 6144
s_nop 0
buffer_load_dwordx4 v8, s[8:11], s40 offen lds
ds_read_b128 v[60:63], v91 offset:0
ds_read_b128 v[64:67], v91 offset:4096
ds_read_b128 v[68:71], v95 offset:0
ds_read_b128 v[72:75], v95 offset:4096
ds_read_b128 v[76:79], v95 offset:8192
ds_read_b128 v[80:83], v95 offset:12288
ds_read_b128 v[84:87], v95 offset:16384
s_waitcnt lgkmcnt(7)
v_mfma_f32_16x16x32_bf16 v[96:99], v[32:35], v[40:43], v[96:99]
v_mfma_f32_16x16x32_bf16 v[100:103], v[32:35], v[44:47], v[100:103]
v_mfma_f32_16x16x32_bf16 v[104:107], v[32:35], v[48:51], v[104:107]
v_mfma_f32_16x16x32_bf16 v[108:111], v[32:35], v[52:55], v[108:111]
v_mfma_f32_16x16x32_bf16 v[112:115], v[32:35], v[56:59], v[112:115]
v_mfma_f32_16x16x32_bf16 v[116:119], v[36:39], v[40:43], v[116:119]
v_mfma_f32_16x16x32_bf16 v[120:123], v[36:39], v[44:47], v[120:123]
v_mfma_f32_16x16x32_bf16 v[124:127], v[36:39], v[48:51], v[124:127]
v_mfma_f32_16x16x32_bf16 v[128:131], v[36:39], v[52:55], v[128:131]
v_mfma_f32_16x16x32_bf16 v[132:135], v[36:39], v[56:59], v[132:135]
s_add_u32 m0, s36, 7168
s_nop 0
buffer_load_dwordx4 v9, s[8:11], s40 offen lds
s_add_u32 m0, s37, 0
s_nop 0
buffer_load_dwordx4 v10, s[12:15], s40 offen lds
s_add_u32 m0, s37, 1024
s_nop 0
buffer_load_dwordx4 v11, s[12:15], s40 offen lds
s_waitcnt lgkmcnt(0)
v_mfma_f32_16x16x32_bf16 v[96:99], v[60:63], v[68:71], v[96:99]
v_mfma_f32_16x16x32_bf16 v[100:103], v[60:63], v[72:75], v[100:103]
v_mfma_f32_16x16x32_bf16 v[104:107], v[60:63], v[76:79], v[104:107]
v_mfma_f32_16x16x32_bf16 v[108:111], v[60:63], v[80:83], v[108:111]
v_mfma_f32_16x16x32_bf16 v[112:115], v[60:63], v[84:87], v[112:115]
v_mfma_f32_16x16x32_bf16 v[116:119], v[64:67], v[68:71], v[116:119]
v_mfma_f32_16x16x32_bf16 v[120:123], v[64:67], v[72:75], v[120:123]
v_mfma_f32_16x16x32_bf16 v[124:127], v[64:67], v[76:79], v[124:127]
v_mfma_f32_16x16x32_bf16 v[128:131], v[64:67], v[80:83], v[128:131]
v_mfma_f32_16x16x32_bf16 v[132:135], v[64:67], v[84:87], v[132:135]
s_add_u32 m0, s37, 2048
s_nop 0
buffer_load_dwordx4 v12, s[12:15], s40 offen lds
s_add_u32 m0, s37, 3072
s_nop 0
buffer_load_dwordx4 v13, s[12:15], s40 offen lds
s_add_u32 m0, s37, 4096
s_nop 0
buffer_load_dwordx4 v14, s[12:15], s40 offen lds
s_waitcnt vmcnt(13)
s_barrier
v_add_u32 v88, 106496, v20
v_add_u32 v92, 106496, v24
v_add_u32 v89, 106496, v21
v_add_u32 v93, 106496, v25
v_add_u32 v90, 106496, v22
v_add_u32 v94, 106496, v26
v_add_u32 v91, 106496, v23
v_add_u32 v95, 106496, v27
s_mov_b32 s40, 3328
ds_read_b128 v[32:35], v88 offset:0
ds_read_b128 v[36:39], v88 offset:4096
ds_read_b128 v[40:43], v92 offset:0
ds_read_b128 v[44:47], v92 offset:4096
ds_read_b128 v[48:51], v92 offset:8192
ds_read_b128 v[52:55], v92 offset:12288
ds_read_b128 v[56:59], v92 offset:16384
ds_read_b128 v[60:63], v89 offset:0
ds_read_b128 v[64:67], v89 offset:4096
ds_read_b128 v[68:71], v93 offset:0
ds_read_b128 v[72:75], v93 offset:4096
ds_read_b128 v[76:79], v93 offset:8192
ds_read_b128 v[80:83], v93 offset:12288
ds_read_b128 v[84:87], v93 offset:16384
s_waitcnt lgkmcnt(7)
v_mfma_f32_16x16x32_bf16 v[96:99], v[32:35], v[40:43], v[96:99]
v_mfma_f32_16x16x32_bf16 v[100:103], v[32:35], v[44:47], v[100:103]
v_mfma_f32_16x16x32_bf16 v[104:107], v[32:35], v[48:51], v[104:107]
v_mfma_f32_16x16x32_bf16 v[108:111], v[32:35], v[52:55], v[108:111]
v_mfma_f32_16x16x32_bf16 v[112:115], v[32:35], v[56:59], v[112:115]
v_mfma_f32_16x16x32_bf16 v[116:119], v[36:39], v[40:43], v[116:119]
v_mfma_f32_16x16x32_bf16 v[120:123], v[36:39], v[44:47], v[120:123]
v_mfma_f32_16x16x32_bf16 v[124:127], v[36:39], v[48:51], v[124:127]
v_mfma_f32_16x16x32_bf16 v[128:131], v[36:39], v[52:55], v[128:131]
v_mfma_f32_16x16x32_bf16 v[132:135], v[36:39], v[56:59], v[132:135]
s_add_u32 m0, s36, 53248
s_nop 0
buffer_load_dwordx4 v2, s[8:11], s40 offen lds
s_add_u32 m0, s36, 54272
s_nop 0
buffer_load_dwordx4 v3, s[8:11], s40 offen lds
s_add_u32 m0, s36, 55296
s_nop 0
buffer_load_dwordx4 v4, s[8:11], s40 offen lds
s_add_u32 m0, s36, 56320
s_nop 0
buffer_load_dwordx4 v5, s[8:11], s40 offen lds
ds_read_b128 v[32:35], v90 offset:0
ds_read_b128 v[36:39], v90 offset:4096
ds_read_b128 v[40:43], v94 offset:0
ds_read_b128 v[44:47], v94 offset:4096
ds_read_b128 v[48:51], v94 offset:8192
ds_read_b128 v[52:55], v94 offset:12288
ds_read_b128 v[56:59], v94 offset:16384
s_waitcnt lgkmcnt(7)
v_mfma_f32_16x16x32_bf16 v[96:99], v[60:63], v[68:71], v[96:99]
v_mfma_f32_16x16x32_bf16 v[100:103], v[60:63], v[72:75], v[100:103]
v_mfma_f32_16x16x32_bf16 v[104:107], v[60:63], v[76:79], v[104:107]
v_mfma_f32_16x16x32_bf16 v[108:111], v[60:63], v[80:83], v[108:111]
v_mfma_f32_16x16x32_bf16 v[112:115], v[60:63], v[84:87], v[112:115]
v_mfma_f32_16x16x32_bf16 v[116:119], v[64:67], v[68:71], v[116:119]
v_mfma_f32_16x16x32_bf16 v[120:123], v[64:67], v[72:75], v[120:123]
v_mfma_f32_16x16x32_bf16 v[124:127], v[64:67], v[76:79], v[124:127]
v_mfma_f32_16x16x32_bf16 v[128:131], v[64:67], v[80:83], v[128:131]
v_mfma_f32_16x16x32_bf16 v[132:135], v[64:67], v[84:87], v[132:135]
s_add_u32 m0, s36, 57344
s_nop 0
buffer_load_dwordx4 v6, s[8:11], s40 offen lds
s_add_u32 m0, s36, 58368
s_nop 0
buffer_load_dwordx4 v7, s[8:11], s40 offen lds
s_add_u32 m0, s36, 59392
s_nop 0
buffer_load_dwordx4 v8, s[8:11], s40 offen lds
ds_read_b128 v[60:63], v91 offset:0
ds_read_b128 v[64:67], v91 offset:4096
ds_read_b128 v[68:71], v95 offset:0
ds_read_b128 v[72:75], v95 offset:4096
ds_read_b128 v[76:79], v95 offset:8192
ds_read_b128 v[80:83], v95 offset:12288
ds_read_b128 v[84:87], v95 offset:16384
s_waitcnt lgkmcnt(7)
v_mfma_f32_16x16x32_bf16 v[96:99], v[32:35], v[40:43], v[96:99]
v_mfma_f32_16x16x32_bf16 v[100:103], v[32:35], v[44:47], v[100:103]
v_mfma_f32_16x16x32_bf16 v[104:107], v[32:35], v[48:51], v[104:107]
v_mfma_f32_16x16x32_bf16 v[108:111], v[32:35], v[52:55], v[108:111]
v_mfma_f32_16x16x32_bf16 v[112:115], v[32:35], v[56:59], v[112:115]
v_mfma_f32_16x16x32_bf16 v[116:119], v[36:39], v[40:43], v[116:119]
v_mfma_f32_16x16x32_bf16 v[120:123], v[36:39], v[44:47], v[120:123]
v_mfma_f32_16x16x32_bf16 v[124:127], v[36:39], v[48:51], v[124:127]
v_mfma_f32_16x16x32_bf16 v[128:131], v[36:39], v[52:55], v[128:131]
v_mfma_f32_16x16x32_bf16 v[132:135], v[36:39], v[56:59], v[132:135]
s_add_u32 m0, s36, 60416
s_nop 0
buffer_load_dwordx4 v9, s[8:11], s40 offen lds
s_add_u32 m0, s37, 53248
s_nop 0
buffer_load_dwordx4 v10, s[12:15], s40 offen lds
s_add_u32 m0, s37, 54272
s_nop 0
buffer_load_dwordx4 v11, s[12:15], s40 offen lds
s_waitcnt lgkmcnt(0)
v_mfma_f32_16x16x32_bf16 v[96:99], v[60:63], v[68:71], v[96:99]
v_mfma_f32_16x16x32_bf16 v[100:103], v[60:63], v[72:75], v[100:103]
v_mfma_f32_16x16x32_bf16 v[104:107], v[60:63], v[76:79], v[104:107]
v_mfma_f32_16x16x32_bf16 v[108:111], v[60:63], v[80:83], v[108:111]
v_mfma_f32_16x16x32_bf16 v[112:115], v[60:63], v[84:87], v[112:115]
v_mfma_f32_16x16x32_bf16 v[116:119], v[64:67], v[68:71], v[116:119]
v_mfma_f32_16x16x32_bf16 v[120:123], v[64:67], v[72:75], v[120:123]
v_mfma_f32_16x16x32_bf16 v[124:127], v[64:67], v[76:79], v[124:127]
v_mfma_f32_16x16x32_bf16 v[128:131], v[64:67], v[80:83], v[128:131]
v_mfma_f32_16x16x32_bf16 v[132:135], v[64:67], v[84:87], v[132:135]
s_add_u32 m0, s37, 55296
s_nop 0
buffer_load_dwordx4 v12, s[12:15], s40 offen lds
s_add_u32 m0, s37, 56320
s_nop 0
buffer_load_dwordx4 v13, s[12:15], s40 offen lds
s_add_u32 m0, s37, 57344
s_nop 0
buffer_load_dwordx4 v14, s[12:15], s40 offen lds
s_waitcnt vmcnt(13)
s_barrier
v_add_u32 v88, 0, v20
v_add_u32 v92, 0, v24
v_add_u32 v89, 0, v21
v_add_u32 v93, 0, v25
v_add_u32 v90, 0, v22
v_add_u32 v94, 0, v26
v_add_u32 v91, 0, v23
v_add_u32 v95, 0, v27
s_mov_b32 s40, 3584
ds_read_b128 v[32:35], v88 offset:0
ds_read_b128 v[36:39], v88 offset:4096
ds_read_b128 v[40:43], v92 offset:0
ds_read_b128 v[44:47], v92 offset:4096
ds_read_b128 v[48:51], v92 offset:8192
ds_read_b128 v[52:55], v92 offset:12288
ds_read_b128 v[56:59], v92 offset:16384
ds_read_b128 v[60:63], v89 offset:0
ds_read_b128 v[64:67], v89 offset:4096
ds_read_b128 v[68:71], v93 offset:0
ds_read_b128 v[72:75], v93 offset:4096
ds_read_b128 v[76:79], v93 offset:8192
ds_read_b128 v[80:83], v93 offset:12288
ds_read_b128 v[84:87], v93 offset:16384
s_waitcnt lgkmcnt(7)
v_mfma_f32_16x16x32_bf16 v[96:99], v[32:35], v[40:43], v[96:99]
v_mfma_f32_16x16x32_bf16 v[100:103], v[32:35], v[44:47], v[100:103]
v_mfma_f32_16x16x32_bf16 v[104:107], v[32:35], v[48:51], v[104:107]
v_mfma_f32_16x16x32_bf16 v[108:111], v[32:35], v[52:55], v[108:111]
v_mfma_f32_16x16x32_bf16 v[112:115], v[32:35], v[56:59], v[112:115]
v_mfma_f32_16x16x32_bf16 v[116:119], v[36:39], v[40:43], v[116:119]
v_mfma_f32_16x16x32_bf16 v[120:123], v[36:39], v[44:47], v[120:123]
v_mfma_f32_16x16x32_bf16 v[124:127], v[36:39], v[48:51], v[124:127]
v_mfma_f32_16x16x32_bf16 v[128:131], v[36:39], v[52:55], v[128:131]
v_mfma_f32_16x16x32_bf16 v[132:135], v[36:39], v[56:59], v[132:135]
s_add_u32 m0, s36, 106496
s_nop 0
buffer_load_dwordx4 v2, s[8:11], s40 offen lds
s_add_u32 m0, s36, 107520
s_nop 0
buffer_load_dwordx4 v3, s[8:11], s40 offen lds
s_add_u32 m0, s36, 108544
s_nop 0
buffer_load_dwordx4 v4, s[8:11], s40 offen lds
s_add_u32 m0, s36, 109568
s_nop 0
buffer_load_dwordx4 v5, s[8:11], s40 offen lds
ds_read_b128 v[32:35], v90 offset:0
ds_read_b128 v[36:39], v90 offset:4096
ds_read_b128 v[40:43], v94 offset:0
ds_read_b128 v[44:47], v94 offset:4096
ds_read_b128 v[48:51], v94 offset:8192
ds_read_b128 v[52:55], v94 offset:12288
ds_read_b128 v[56:59], v94 offset:16384
s_waitcnt lgkmcnt(7)
v_mfma_f32_16x16x32_bf16 v[96:99], v[60:63], v[68:71], v[96:99]
v_mfma_f32_16x16x32_bf16 v[100:103], v[60:63], v[72:75], v[100:103]
v_mfma_f32_16x16x32_bf16 v[104:107], v[60:63], v[76:79], v[104:107]
v_mfma_f32_16x16x32_bf16 v[108:111], v[60:63], v[80:83], v[108:111]
v_mfma_f32_16x16x32_bf16 v[112:115], v[60:63], v[84:87], v[112:115]
v_mfma_f32_16x16x32_bf16 v[116:119], v[64:67], v[68:71], v[116:119]
v_mfma_f32_16x16x32_bf16 v[120:123], v[64:67], v[72:75], v[120:123]
v_mfma_f32_16x16x32_bf16 v[124:127], v[64:67], v[76:79], v[124:127]
v_mfma_f32_16x16x32_bf16 v[128:131], v[64:67], v[80:83], v[128:131]
v_mfma_f32_16x16x32_bf16 v[132:135], v[64:67], v[84:87], v[132:135]
s_add_u32 m0, s36, 110592
s_nop 0
buffer_load_dwordx4 v6, s[8:11], s40 offen lds
s_add_u32 m0, s36, 111616
s_nop 0
buffer_load_dwordx4 v7, s[8:11], s40 offen lds
s_add_u32 m0, s36, 112640
s_nop 0
buffer_load_dwordx4 v8, s[8:11], s40 offen lds
ds_read_b128 v[60:63], v91 offset:0
ds_read_b128 v[64:67], v91 offset:4096
ds_read_b128 v[68:71], v95 offset:0
ds_read_b128 v[72:75], v95 offset:4096
ds_read_b128 v[76:79], v95 offset:8192
ds_read_b128 v[80:83], v95 offset:12288
ds_read_b128 v[84:87], v95 offset:16384
s_waitcnt lgkmcnt(7)
v_mfma_f32_16x16x32_bf16 v[96:99], v[32:35], v[40:43], v[96:99]
v_mfma_f32_16x16x32_bf16 v[100:103], v[32:35], v[44:47], v[100:103]
v_mfma_f32_16x16x32_bf16 v[104:107], v[32:35], v[48:51], v[104:107]
v_mfma_f32_16x16x32_bf16 v[108:111], v[32:35], v[52:55], v[108:111]
v_mfma_f32_16x16x32_bf16 v[112:115], v[32:35], v[56:59], v[112:115]
v_mfma_f32_16x16x32_bf16 v[116:119], v[36:39], v[40:43], v[116:119]
v_mfma_f32_16x16x32_bf16 v[120:123], v[36:39], v[44:47], v[120:123]
v_mfma_f32_16x16x32_bf16 v[124:127], v[36:39], v[48:51], v[124:127]
v_mfma_f32_16x16x32_bf16 v[128:131], v[36:39], v[52:55], v[128:131]
v_mfma_f32_16x16x32_bf16 v[132:135], v[36:39], v[56:59], v[132:135]
s_add_u32 m0, s36, 113664
s_nop 0
buffer_load_dwordx4 v9, s[8:11], s40 offen lds
s_add_u32 m0, s37, 106496
s_nop 0
buffer_load_dwordx4 v10, s[12:15], s40 offen lds
s_add_u32 m0, s37, 107520
s_nop 0
buffer_load_dwordx4 v11, s[12:15], s40 offen lds
s_waitcnt lgkmcnt(0)
v_mfma_f32_16x16x32_bf16 v[96:99], v[60:63], v[68:71], v[96:99]
v_mfma_f32_16x16x32_bf16 v[100:103], v[60:63], v[72:75], v[100:103]
v_mfma_f32_16x16x32_bf16 v[104:107], v[60:63], v[76:79], v[104:107]
v_mfma_f32_16x16x32_bf16 v[108:111], v[60:63], v[80:83], v[108:111]
v_mfma_f32_16x16x32_bf16 v[112:115], v[60:63], v[84:87], v[112:115]
v_mfma_f32_16x16x32_bf16 v[116:119], v[64:67], v[68:71], v[116:119]
v_mfma_f32_16x16x32_bf16 v[120:123], v[64:67], v[72:75], v[120:123]
v_mfma_f32_16x16x32_bf16 v[124:127], v[64:67], v[76:79], v[124:127]
v_mfma_f32_16x16x32_bf16 v[128:131], v[64:67], v[80:83], v[128:131]
v_mfma_f32_16x16x32_bf16 v[132:135], v[64:67], v[84:87], v[132:135]
s_add_u32 m0, s37, 108544
s_nop 0
buffer_load_dwordx4 v12, s[12:15], s40 offen lds
s_add_u32 m0, s37, 109568
s_nop 0
buffer_load_dwordx4 v13, s[12:15], s40 offen lds
s_add_u32 m0, s37, 110592
s_nop 0
buffer_load_dwordx4 v14, s[12:15], s40 offen lds
s_waitcnt vmcnt(13)
s_barrier
v_add_u32 v88, 53248, v20
v_add_u32 v92, 53248, v24
v_add_u32 v89, 53248, v21
v_add_u32 v93, 53248, v25
v_add_u32 v90, 53248, v22
v_add_u32 v94, 53248, v26
v_add_u32 v91, 53248, v23
v_add_u32 v95, 53248, v27
s_mov_b32 s40, 3840
ds_read_b128 v[32:35], v88 offset:0
ds_read_b128 v[36:39], v88 offset:4096
ds_read_b128 v[40:43], v92 offset:0
ds_read_b128 v[44:47], v92 offset:4096
ds_read_b128 v[48:51], v92 offset:8192
ds_read_b128 v[52:55], v92 offset:12288
ds_read_b128 v[56:59], v92 offset:16384
ds_read_b128 v[60:63], v89 offset:0
ds_read_b128 v[64:67], v89 offset:4096
ds_read_b128 v[68:71], v93 offset:0
ds_read_b128 v[72:75], v93 offset:4096
ds_read_b128 v[76:79], v93 offset:8192
ds_read_b128 v[80:83], v93 offset:12288
ds_read_b128 v[84:87], v93 offset:16384
s_waitcnt lgkmcnt(7)
v_mfma_f32_16x16x32_bf16 v[96:99], v[32:35], v[40:43], v[96:99]
v_mfma_f32_16x16x32_bf16 v[100:103], v[32:35], v[44:47], v[100:103]
v_mfma_f32_16x16x32_bf16 v[104:107], v[32:35], v[48:51], v[104:107]
v_mfma_f32_16x16x32_bf16 v[108:111], v[32:35], v[52:55], v[108:111]
v_mfma_f32_16x16x32_bf16 v[112:115], v[32:35], v[56:59], v[112:115]
v_mfma_f32_16x16x32_bf16 v[116:119], v[36:39], v[40:43], v[116:119]
v_mfma_f32_16x16x32_bf16 v[120:123], v[36:39], v[44:47], v[120:123]
v_mfma_f32_16x16x32_bf16 v[124:127], v[36:39], v[48:51], v[124:127]
v_mfma_f32_16x16x32_bf16 v[128:131], v[36:39], v[52:55], v[128:131]
v_mfma_f32_16x16x32_bf16 v[132:135], v[36:39], v[56:59], v[132:135]
s_add_u32 m0, s36, 0
s_nop 0
buffer_load_dwordx4 v2, s[8:11], s40 offen lds
s_add_u32 m0, s36, 1024
s_nop 0
buffer_load_dwordx4 v3, s[8:11], s40 offen lds
s_add_u32 m0, s36, 2048
s_nop 0
buffer_load_dwordx4 v4, s[8:11], s40 offen lds
s_add_u32 m0, s36, 3072
s_nop 0
buffer_load_dwordx4 v5, s[8:11], s40 offen lds
ds_read_b128 v[32:35], v90 offset:0
ds_read_b128 v[36:39], v90 offset:4096
ds_read_b128 v[40:43], v94 offset:0
ds_read_b128 v[44:47], v94 offset:4096
ds_read_b128 v[48:51], v94 offset:8192
ds_read_b128 v[52:55], v94 offset:12288
ds_read_b128 v[56:59], v94 offset:16384
s_waitcnt lgkmcnt(7)
v_mfma_f32_16x16x32_bf16 v[96:99], v[60:63], v[68:71], v[96:99]
v_mfma_f32_16x16x32_bf16 v[100:103], v[60:63], v[72:75], v[100:103]
v_mfma_f32_16x16x32_bf16 v[104:107], v[60:63], v[76:79], v[104:107]
v_mfma_f32_16x16x32_bf16 v[108:111], v[60:63], v[80:83], v[108:111]
v_mfma_f32_16x16x32_bf16 v[112:115], v[60:63], v[84:87], v[112:115]
v_mfma_f32_16x16x32_bf16 v[116:119], v[64:67], v[68:71], v[116:119]
v_mfma_f32_16x16x32_bf16 v[120:123], v[64:67], v[72:75], v[120:123]
v_mfma_f32_16x16x32_bf16 v[124:127], v[64:67], v[76:79], v[124:127]
v_mfma_f32_16x16x32_bf16 v[128:131], v[64:67], v[80:83], v[128:131]
v_mfma_f32_16x16x32_bf16 v[132:135], v[64:67], v[84:87], v[132:135]
s_add_u32 m0, s36, 4096
s_nop 0
buffer_load_dwordx4 v6, s[8:11], s40 offen lds
s_add_u32 m0, s36, 5120
s_nop 0
buffer_load_dwordx4 v7, s[8:11], s40 offen lds
s_add_u32 m0, s36, 6144
s_nop 0
buffer_load_dwordx4 v8, s[8:11], s40 offen lds
ds_read_b128 v[60:63], v91 offset:0
ds_read_b128 v[64:67], v91 offset:4096
ds_read_b128 v[68:71], v95 offset:0
ds_read_b128 v[72:75], v95 offset:4096
ds_read_b128 v[76:79], v95 offset:8192
ds_read_b128 v[80:83], v95 offset:12288
ds_read_b128 v[84:87], v95 offset:16384
s_waitcnt lgkmcnt(7)
v_mfma_f32_16x16x32_bf16 v[96:99], v[32:35], v[40:43], v[96:99]
v_mfma_f32_16x16x32_bf16 v[100:103], v[32:35], v[44:47], v[100:103]
v_mfma_f32_16x16x32_bf16 v[104:107], v[32:35], v[48:51], v[104:107]
v_mfma_f32_16x16x32_bf16 v[108:111], v[32:35], v[52:55], v[108:111]
v_mfma_f32_16x16x32_bf16 v[112:115], v[32:35], v[56:59], v[112:115]
v_mfma_f32_16x16x32_bf16 v[116:119], v[36:39], v[40:43], v[116:119]
v_mfma_f32_16x16x32_bf16 v[120:123], v[36:39], v[44:47], v[120:123]
v_mfma_f32_16x16x32_bf16 v[124:127], v[36:39], v[48:51], v[124:127]
v_mfma_f32_16x16x32_bf16 v[128:131], v[36:39], v[52:55], v[128:131]
v_mfma_f32_16x16x32_bf16 v[132:135], v[36:39], v[56:59], v[132:135]
s_add_u32 m0, s36, 7168
s_nop 0
buffer_load_dwordx4 v9, s[8:11], s40 offen lds
s_add_u32 m0, s37, 0
s_nop 0
buffer_load_dwordx4 v10, s[12:15], s40 offen lds
s_add_u32 m0, s37, 1024
s_nop 0
buffer_load_dwordx4 v11, s[12:15], s40 offen lds
s_waitcnt lgkmcnt(0)
v_mfma_f32_16x16x32_bf16 v[96:99], v[60:63], v[68:71], v[96:99]
v_mfma_f32_16x16x32_bf16 v[100:103], v[60:63], v[72:75], v[100:103]
v_mfma_f32_16x16x32_bf16 v[104:107], v[60:63], v[76:79], v[104:107]
v_mfma_f32_16x16x32_bf16 v[108:111], v[60:63], v[80:83], v[108:111]
v_mfma_f32_16x16x32_bf16 v[112:115], v[60:63], v[84:87], v[112:115]
v_mfma_f32_16x16x32_bf16 v[116:119], v[64:67], v[68:71], v[116:119]
v_mfma_f32_16x16x32_bf16 v[120:123], v[64:67], v[72:75], v[120:123]
v_mfma_f32_16x16x32_bf16 v[124:127], v[64:67], v[76:79], v[124:127]
v_mfma_f32_16x16x32_bf16 v[128:131], v[64:67], v[80:83], v[128:131]
v_mfma_f32_16x16x32_bf16 v[132:135], v[64:67], v[84:87], v[132:135]
s_add_u32 m0, s37, 2048
s_nop 0
buffer_load_dwordx4 v12, s[12:15], s40 offen lds
s_add_u32 m0, s37, 3072
s_nop 0
buffer_load_dwordx4 v13, s[12:15], s40 offen lds
s_add_u32 m0, s37, 4096
s_nop 0
buffer_load_dwordx4 v14, s[12:15], s40 offen lds
s_waitcnt vmcnt(13)
s_barrier
v_add_u32 v88, 106496, v20
v_add_u32 v92, 106496, v24
v_add_u32 v89, 106496, v21
v_add_u32 v93, 106496, v25
v_add_u32 v90, 106496, v22
v_add_u32 v94, 106496, v26
v_add_u32 v91, 106496, v23
v_add_u32 v95, 106496, v27
ds_read_b128 v[32:35], v88 offset:0
ds_read_b128 v[36:39], v88 offset:4096
ds_read_b128 v[40:43], v92 offset:0
ds_read_b128 v[44:47], v92 offset:4096
ds_read_b128 v[48:51], v92 offset:8192
ds_read_b128 v[52:55], v92 offset:12288
ds_read_b128 v[56:59], v92 offset:16384
ds_read_b128 v[60:63], v89 offset:0
ds_read_b128 v[64:67], v89 offset:4096
ds_read_b128 v[68:71], v93 offset:0
ds_read_b128 v[72:75], v93 offset:4096
ds_read_b128 v[76:79], v93 offset:8192
ds_read_b128 v[80:83], v93 offset:12288
ds_read_b128 v[84:87], v93 offset:16384
s_waitcnt lgkmcnt(7)
v_mfma_f32_16x16x32_bf16 v[96:99], v[32:35], v[40:43], v[96:99]
v_mfma_f32_16x16x32_bf16 v[100:103], v[32:35], v[44:47], v[100:103]
v_mfma_f32_16x16x32_bf16 v[104:107], v[32:35], v[48:51], v[104:107]
v_mfma_f32_16x16x32_bf16 v[108:111], v[32:35], v[52:55], v[108:111]
v_mfma_f32_16x16x32_bf16 v[112:115], v[32:35], v[56:59], v[112:115]
v_mfma_f32_16x16x32_bf16 v[116:119], v[36:39], v[40:43], v[116:119]
v_mfma_f32_16x16x32_bf16 v[120:123], v[36:39], v[44:47], v[120:123]
v_mfma_f32_16x16x32_bf16 v[124:127], v[36:39], v[48:51], v[124:127]
v_mfma_f32_16x16x32_bf16 v[128:131], v[36:39], v[52:55], v[128:131]
v_mfma_f32_16x16x32_bf16 v[132:135], v[36:39], v[56:59], v[132:135]
ds_read_b128 v[32:35], v90 offset:0
ds_read_b128 v[36:39], v90 offset:4096
ds_read_b128 v[40:43], v94 offset:0
ds_read_b128 v[44:47], v94 offset:4096
ds_read_b128 v[48:51], v94 offset:8192
ds_read_b128 v[52:55], v94 offset:12288
ds_read_b128 v[56:59], v94 offset:16384
s_waitcnt lgkmcnt(7)
v_mfma_f32_16x16x32_bf16 v[96:99], v[60:63], v[68:71], v[96:99]
v_mfma_f32_16x16x32_bf16 v[100:103], v[60:63], v[72:75], v[100:103]
v_mfma_f32_16x16x32_bf16 v[104:107], v[60:63], v[76:79], v[104:107]
v_mfma_f32_16x16x32_bf16 v[108:111], v[60:63], v[80:83], v[108:111]
v_mfma_f32_16x16x32_bf16 v[112:115], v[60:63], v[84:87], v[112:115]
v_mfma_f32_16x16x32_bf16 v[116:119], v[64:67], v[68:71], v[116:119]
v_mfma_f32_16x16x32_bf16 v[120:123], v[64:67], v[72:75], v[120:123]
v_mfma_f32_16x16x32_bf16 v[124:127], v[64:67], v[76:79], v[124:127]
v_mfma_f32_16x16x32_bf16 v[128:131], v[64:67], v[80:83], v[128:131]
v_mfma_f32_16x16x32_bf16 v[132:135], v[64:67], v[84:87], v[132:135]
ds_read_b128 v[60:63], v91 offset:0
ds_read_b128 v[64:67], v91 offset:4096
ds_read_b128 v[68:71], v95 offset:0
ds_read_b128 v[72:75], v95 offset:4096
ds_read_b128 v[76:79], v95 offset:8192
ds_read_b128 v[80:83], v95 offset:12288
ds_read_b128 v[84:87], v95 offset:16384
s_waitcnt lgkmcnt(7)
v_mfma_f32_16x16x32_bf16 v[96:99], v[32:35], v[40:43], v[96:99]
v_mfma_f32_16x16x32_bf16 v[100:103], v[32:35], v[44:47], v[100:103]
v_mfma_f32_16x16x32_bf16 v[104:107], v[32:35], v[48:51], v[104:107]
v_mfma_f32_16x16x32_bf16 v[108:111], v[32:35], v[52:55], v[108:111]
v_mfma_f32_16x16x32_bf16 v[112:115], v[32:35], v[56:59], v[112:115]
v_mfma_f32_16x16x32_bf16 v[116:119], v[36:39], v[40:43], v[116:119]
v_mfma_f32_16x16x32_bf16 v[120:123], v[36:39], v[44:47], v[120:123]
v_mfma_f32_16x16x32_bf16 v[124:127], v[36:39], v[48:51], v[124:127]
v_mfma_f32_16x16x32_bf16 v[128:131], v[36:39], v[52:55], v[128:131]
v_mfma_f32_16x16x32_bf16 v[132:135], v[36:39], v[56:59], v[132:135]
s_waitcnt lgkmcnt(0)
v_mfma_f32_16x16x32_bf16 v[96:99], v[60:63], v[68:71], v[96:99]
v_mfma_f32_16x16x32_bf16 v[100:103], v[60:63], v[72:75], v[100:103]
v_mfma_f32_16x16x32_bf16 v[104:107], v[60:63], v[76:79], v[104:107]
v_mfma_f32_16x16x32_bf16 v[108:111], v[60:63], v[80:83], v[108:111]
v_mfma_f32_16x16x32_bf16 v[112:115], v[60:63], v[84:87], v[112:115]
v_mfma_f32_16x16x32_bf16 v[116:119], v[64:67], v[68:71], v[116:119]
v_mfma_f32_16x16x32_bf16 v[120:123], v[64:67], v[72:75], v[120:123]
v_mfma_f32_16x16x32_bf16 v[124:127], v[64:67], v[76:79], v[124:127]
v_mfma_f32_16x16x32_bf16 v[128:131], v[64:67], v[80:83], v[128:131]
v_mfma_f32_16x16x32_bf16 v[132:135], v[64:67], v[84:87], v[132:135]
s_waitcnt vmcnt(0)
s_barrier
v_add_u32 v88, 0, v20
v_add_u32 v92, 0, v24
v_add_u32 v89, 0, v21
v_add_u32 v93, 0, v25
v_add_u32 v90, 0, v22
v_add_u32 v94, 0, v26
v_add_u32 v91, 0, v23
v_add_u32 v95, 0, v27
ds_read_b128 v[32:35], v88 offset:0
ds_read_b128 v[36:39], v88 offset:4096
ds_read_b128 v[40:43], v92 offset:0
ds_read_b128 v[44:47], v92 offset:4096
ds_read_b128 v[48:51], v92 offset:8192
ds_read_b128 v[52:55], v92 offset:12288
ds_read_b128 v[56:59], v92 offset:16384
ds_read_b128 v[60:63], v89 offset:0
ds_read_b128 v[64:67], v89 offset:4096
ds_read_b128 v[68:71], v93 offset:0
ds_read_b128 v[72:75], v93 offset:4096
ds_read_b128 v[76:79], v93 offset:8192
ds_read_b128 v[80:83], v93 offset:12288
ds_read_b128 v[84:87], v93 offset:16384
s_waitcnt lgkmcnt(7)
v_mfma_f32_16x16x32_bf16 v[96:99], v[32:35], v[40:43], v[96:99]
v_mfma_f32_16x16x32_bf16 v[100:103], v[32:35], v[44:47], v[100:103]
v_mfma_f32_16x16x32_bf16 v[104:107], v[32:35], v[48:51], v[104:107]
v_mfma_f32_16x16x32_bf16 v[108:111], v[32:35], v[52:55], v[108:111]
v_mfma_f32_16x16x32_bf16 v[112:115], v[32:35], v[56:59], v[112:115]
v_mfma_f32_16x16x32_bf16 v[116:119], v[36:39], v[40:43], v[116:119]
v_mfma_f32_16x16x32_bf16 v[120:123], v[36:39], v[44:47], v[120:123]
v_mfma_f32_16x16x32_bf16 v[124:127], v[36:39], v[48:51], v[124:127]
v_mfma_f32_16x16x32_bf16 v[128:131], v[36:39], v[52:55], v[128:131]
v_mfma_f32_16x16x32_bf16 v[132:135], v[36:39], v[56:59], v[132:135]
ds_read_b128 v[32:35], v90 offset:0
ds_read_b128 v[36:39], v90 offset:4096
ds_read_b128 v[40:43], v94 offset:0
ds_read_b128 v[44:47], v94 offset:4096
ds_read_b128 v[48:51], v94 offset:8192
ds_read_b128 v[52:55], v94 offset:12288
ds_read_b128 v[56:59], v94 offset:16384
s_waitcnt lgkmcnt(7)
v_mfma_f32_16x16x32_bf16 v[96:99], v[60:63], v[68:71], v[96:99]
v_mfma_f32_16x16x32_bf16 v[100:103], v[60:63], v[72:75], v[100:103]
v_mfma_f32_16x16x32_bf16 v[104:107], v[60:63], v[76:79], v[104:107]
v_mfma_f32_16x16x32_bf16 v[108:111], v[60:63], v[80:83], v[108:111]
v_mfma_f32_16x16x32_bf16 v[112:115], v[60:63], v[84:87], v[112:115]
v_mfma_f32_16x16x32_bf16 v[116:119], v[64:67], v[68:71], v[116:119]
v_mfma_f32_16x16x32_bf16 v[120:123], v[64:67], v[72:75], v[120:123]
v_mfma_f32_16x16x32_bf16 v[124:127], v[64:67], v[76:79], v[124:127]
v_mfma_f32_16x16x32_bf16 v[128:131], v[64:67], v[80:83], v[128:131]
v_mfma_f32_16x16x32_bf16 v[132:135], v[64:67], v[84:87], v[132:135]
ds_read_b128 v[60:63], v91 offset:0
ds_read_b128 v[64:67], v91 offset:4096
ds_read_b128 v[68:71], v95 offset:0
ds_read_b128 v[72:75], v95 offset:4096
ds_read_b128 v[76:79], v95 offset:8192
ds_read_b128 v[80:83], v95 offset:12288
ds_read_b128 v[84:87], v95 offset:16384
s_waitcnt lgkmcnt(7)
v_mfma_f32_16x16x32_bf16 v[96:99], v[32:35], v[40:43], v[96:99]
v_mfma_f32_16x16x32_bf16 v[100:103], v[32:35], v[44:47], v[100:103]
v_mfma_f32_16x16x32_bf16 v[104:107], v[32:35], v[48:51], v[104:107]
v_mfma_f32_16x16x32_bf16 v[108:111], v[32:35], v[52:55], v[108:111]
v_mfma_f32_16x16x32_bf16 v[112:115], v[32:35], v[56:59], v[112:115]
v_mfma_f32_16x16x32_bf16 v[116:119], v[36:39], v[40:43], v[116:119]
v_mfma_f32_16x16x32_bf16 v[120:123], v[36:39], v[44:47], v[120:123]
v_mfma_f32_16x16x32_bf16 v[124:127], v[36:39], v[48:51], v[124:127]
v_mfma_f32_16x16x32_bf16 v[128:131], v[36:39], v[52:55], v[128:131]
v_mfma_f32_16x16x32_bf16 v[132:135], v[36:39], v[56:59], v[132:135]
s_waitcnt lgkmcnt(0)
v_mfma_f32_16x16x32_bf16 v[96:99], v[60:63], v[68:71], v[96:99]
v_mfma_f32_16x16x32_bf16 v[100:103], v[60:63], v[72:75], v[100:103]
v_mfma_f32_16x16x32_bf16 v[104:107], v[60:63], v[76:79], v[104:107]
v_mfma_f32_16x16x32_bf16 v[108:111], v[60:63], v[80:83], v[108:111]
v_mfma_f32_16x16x32_bf16 v[112:115], v[60:63], v[84:87], v[112:115]
v_mfma_f32_16x16x32_bf16 v[116:119], v[64:67], v[68:71], v[116:119]
v_mfma_f32_16x16x32_bf16 v[120:123], v[64:67], v[72:75], v[120:123]
v_mfma_f32_16x16x32_bf16 v[124:127], v[64:67], v[76:79], v[124:127]
v_mfma_f32_16x16x32_bf16 v[128:131], v[64:67], v[80:83], v[128:131]
v_mfma_f32_16x16x32_bf16 v[132:135], v[64:67], v[84:87], v[132:135]
s_nop 7
s_nop 7
v_mul_u32_u24 v30, 5120, v16
v_lshlrev_b32 v31, 1, v17
v_add_u32 v30, v30, v31
s_mul_i32 s38, s35, 32*1280
v_add_u32 v30, s38, v30
v_cvt_pk_bf16_f32 v32, v96, v97
v_cvt_pk_bf16_f32 v33, v98, v99
s_mov_b32 s41, 0
buffer_store_short v32, v30, s[16:19], s41 offen
buffer_store_short_d16_hi v32, v30, s[16:19], s41 offen offset:1280
buffer_store_short v33, v30, s[16:19], s41 offen offset:2560
buffer_store_short_d16_hi v33, v30, s[16:19], s41 offen offset:3840
s_nop 1
v_cvt_pk_bf16_f32 v32, v100, v101
v_cvt_pk_bf16_f32 v33, v102, v103
s_mov_b32 s41, 32
buffer_store_short v32, v30, s[16:19], s41 offen
buffer_store_short_d16_hi v32, v30, s[16:19], s41 offen offset:1280
buffer_store_short v33, v30, s[16:19], s41 offen offset:2560
buffer_store_short_d16_hi v33, v30, s[16:19], s41 offen offset:3840
s_nop 1
v_cvt_pk_bf16_f32 v32, v104, v105
v_cvt_pk_bf16_f32 v33, v106, v107
s_mov_b32 s41, 64
buffer_store_short v32, v30, s[16:19], s41 offen
buffer_store_short_d16_hi v32, v30, s[16:19], s41 offen offset:1280
buffer_store_short v33, v30, s[16:19], s41 offen offset:2560
buffer_store_short_d16_hi v33, v30, s[16:19], s41 offen offset:3840
s_nop 1
v_cvt_pk_bf16_f32 v32, v108, v109
v_cvt_pk_bf16_f32 v33, v110, v111
s_mov_b32 s41, 96
buffer_store_short v32, v30, s[16:19], s41 offen
buffer_store_short_d16_hi v32, v30, s[16:19], s41 offen offset:1280
buffer_store_short v33, v30, s[16:19], s41 offen offset:2560
buffer_store_short_d16_hi v33, v30, s[16:19], s41 offen offset:3840
s_nop 1
v_cvt_pk_bf16_f32 v32, v112, v113
v_cvt_pk_bf16_f32 v33, v114, v115
s_mov_b32 s41, 128
buffer_store_short v32, v30, s[16:19], s41 offen
buffer_store_short_d16_hi v32, v30, s[16:19], s41 offen offset:1280
buffer_store_short v33, v30, s[16:19], s41 offen offset:2560
buffer_store_short_d16_hi v33, v30, s[16:19], s41 offen offset:3840
s_nop 1
v_cvt_pk_bf16_f32 v32, v116, v117
v_cvt_pk_bf16_f32 v33, v118, v119
s_mov_b32 s41, 20480
buffer_store_short v32, v30, s[16:19], s41 offen
buffer_store_short_d16_hi v32, v30, s[16:19], s41 offen offset:1280
buffer_store_short v33, v30, s[16:19], s41 offen offset:2560
buffer_store_short_d16_hi v33, v30, s[16:19], s41 offen offset:3840
s_nop 1
v_cvt_pk_bf16_f32 v32, v120, v121
v_cvt_pk_bf16_f32 v33, v122, v123
s_mov_b32 s41, 20512
buffer_store_short v32, v30, s[16:19], s41 offen
buffer_store_short_d16_hi v32, v30, s[16:19], s41 offen offset:1280
buffer_store_short v33, v30, s[16:19], s41 offen offset:2560
buffer_store_short_d16_hi v33, v30, s[16:19], s41 offen offset:3840
s_nop 1
v_cvt_pk_bf16_f32 v32, v124, v125
v_cvt_pk_bf16_f32 v33, v126, v127
s_mov_b32 s41, 20544
buffer_store_short v32, v30, s[16:19], s41 offen
buffer_store_short_d16_hi v32, v30, s[16:19], s41 offen offset:1280
buffer_store_short v33, v30, s[16:19], s41 offen offset:2560
buffer_store_short_d16_hi v33, v30, s[16:19], s41 offen offset:3840
s_nop 1
v_cvt_pk_bf16_f32 v32, v128, v129
v_cvt_pk_bf16_f32 v33, v130, v131
s_mov_b32 s41, 20576
buffer_store_short v32, v30, s[16:19], s41 offen
buffer_store_short_d16_hi v32, v30, s[16:19], s41 offen offset:1280
buffer_store_short v33, v30, s[16:19], s41 offen offset:2560
buffer_store_short_d16_hi v33, v30, s[16:19], s41 offen offset:3840
s_nop 1
v_cvt_pk_bf16_f32 v32, v132, v133
v_cvt_pk_bf16_f32 v33, v134, v135
s_mov_b32 s41, 20608
buffer_store_short v32, v30, s[16:19], s41 offen
buffer_store_short_d16_hi v32, v30, s[16:19], s41 offen offset:1280
buffer_store_short v33, v30, s[16:19], s41 offen offset:2560
buffer_store_short_d16_hi v33, v30, s[16:19], s41 offen offset:3840
s_nop 1
g2_kernel_done:
s_endpgm
.p2align 8
cb_kernel:
s_cmp_ge_u32 s2, 640
s_cbranch_scc1 cb_kernel_done
s_load_dwordx2 s[4:5], s[0:1], 88
s_load_dwordx2 s[6:7], s[0:1], 104
s_waitcnt lgkmcnt(0)
s_add_u32 s6, s6, 0x800000
s_addc_u32 s7, s7, 0
s_mov_b32 s8, s4
s_and_b32 s9, s5, 0xffff
s_mov_b32 s10, 0x7fffffff
s_mov_b32 s11, 0x20000
s_mov_b32 s12, s6
s_and_b32 s13, s7, 0xffff
s_mov_b32 s14, 0x7fffffff
s_mov_b32 s15, 0x20000
s_lshl_b32 s3, s2, 8
v_add_u32 v1, s3, v0
s_mov_b32 s20, 53687092
v_mul_hi_u32 v2, v1, s20
v_mul_u32_u24 v3, 80, v2
v_sub_u32 v3, v1, v3
v_lshlrev_b32 v4, 4, v1
s_mov_b32 s21, 2621440
buffer_load_dwordx4 v[8:11], v4, s[12:15], 0 offen
buffer_load_dwordx4 v[12:15], v4, s[12:15], s21 offen
v_mul_u32_u24 v5, 2560, v2
v_lshlrev_b32 v6, 4, v3
v_add_u32 v5, v5, v6
v_add_u32 v5, 1280, v5
s_waitcnt vmcnt(0)
v_lshlrev_b32 v16, 16, v8
v_lshlrev_b32 v17, 16, v12
v_and_b32 v18, 0xffff0000, v8
v_and_b32 v19, 0xffff0000, v12
v_sub_f32 v16, v16, v17
v_sub_f32 v18, v18, v19
v_cvt_pk_bf16_f32 v20, v16, v18
v_lshlrev_b32 v16, 16, v9
v_lshlrev_b32 v17, 16, v13
v_and_b32 v18, 0xffff0000, v9
v_and_b32 v19, 0xffff0000, v13
v_sub_f32 v16, v16, v17
v_sub_f32 v18, v18, v19
v_cvt_pk_bf16_f32 v21, v16, v18
v_lshlrev_b32 v16, 16, v10
v_lshlrev_b32 v17, 16, v14
v_and_b32 v18, 0xffff0000, v10
v_and_b32 v19, 0xffff0000, v14
v_sub_f32 v16, v16, v17
v_sub_f32 v18, v18, v19
v_cvt_pk_bf16_f32 v22, v16, v18
v_lshlrev_b32 v16, 16, v11
v_lshlrev_b32 v17, 16, v15
v_and_b32 v18, 0xffff0000, v11
v_and_b32 v19, 0xffff0000, v15
v_sub_f32 v16, v16, v17
v_sub_f32 v18, v18, v19
v_cvt_pk_bf16_f32 v23, v16, v18
buffer_store_dwordx4 v[20:23], v5, s[8:11], 0 offen
cb_kernel_done:
s_endpgm
.p2align 8
pa_kernel:
s_cmp_ge_u32 s2, 160
s_cbranch_scc1 pa_kernel_done
s_load_dwordx8 s[4:11], s[0:1], 0
s_load_dwordx4 s[12:15], s[0:1], 32
s_load_dwordx2 s[16:17], s[0:1], 88
s_waitcnt lgkmcnt(0)
s_lshl_b32 s3, s2, 5
s_add_u32 s10, s10, s3
s_addc_u32 s11, s11, 0
s_lshl_b32 s3, s2, 3
s_add_u32 s14, s14, s3
s_addc_u32 s15, s15, 0
s_load_dwordx8 s[40:47], s[10:11], 0
s_load_dwordx2 s[48:49], s[14:15], 0
s_mov_b32 s20, s4
s_and_b32 s21, s5, 0xffff
s_mov_b32 s22, 0x7fffffff
s_mov_b32 s23, 0x20000
s_mov_b32 s22, 2621440
s_mov_b32 s24, s6
s_and_b32 s25, s7, 0xffff
s_mov_b32 s26, 0x7fffffff
s_mov_b32 s27, 0x20000
s_mov_b32 s26, 2621440
s_mov_b32 s28, s8
s_and_b32 s29, s9, 0xffff
s_mov_b32 s30, 0x7fffffff
s_mov_b32 s31, 0x20000
s_mov_b32 s30, 2621440
s_mov_b32 s32, s16
s_and_b32 s33, s17, 0xffff
s_mov_b32 s34, 0x7fffffff
s_mov_b32 s35, 0x20000
v_lshrrev_b32 v1, 6, v0
v_and_b32 v2, 63, v0
s_nop 0
v_readfirstlane_b32 s19, v1
s_lshl_b32 s3, s2, 2
s_add_u32 s3, s3, s19
s_lshl_b32 s3, s3, 12
s_add_u32 s12, s12, s3
s_addc_u32 s13, s13, 0
s_mov_b32 s36, s12
s_and_b32 s37, s13, 0xffff
s_mov_b32 s38, 0x7fffffff
s_mov_b32 s39, 0x20000
s_waitcnt lgkmcnt(0)
s_lshl_b32 s52, s40, 16
s_and_b32 s53, s40, 0xffff0000
s_lshl_b32 s54, s41, 16
s_and_b32 s55, s41, 0xffff0000
s_lshl_b32 s68, s48, 16
s_lshl_b32 s56, s42, 16
s_and_b32 s57, s42, 0xffff0000
s_lshl_b32 s58, s43, 16
s_and_b32 s59, s43, 0xffff0000
s_and_b32 s69, s48, 0xffff0000
s_lshl_b32 s60, s44, 16
s_and_b32 s61, s44, 0xffff0000
s_lshl_b32 s62, s45, 16
s_and_b32 s63, s45, 0xffff0000
s_lshl_b32 s70, s49, 16
s_lshl_b32 s64, s46, 16
s_and_b32 s65, s46, 0xffff0000
s_lshl_b32 s66, s47, 16
s_and_b32 s67, s47, 0xffff0000
s_and_b32 s71, s49, 0xffff0000
v_mul_u32_u24 v3, 10240, v0
s_lshl_b32 s3, s2, 3
v_add_u32 v3, s3, v3
v_subrev_u32 v4, 3840, v3
v_add_u32 v5, 0, v4
buffer_load_dwordx2 v[10:11], v5, s[24:27], 0 offen
v_add_u32 v5, 1280, v4
buffer_load_dwordx2 v[12:13], v5, s[24:27], 0 offen
v_add_u32 v5, 2560, v4
buffer_load_dwordx2 v[14:15], v5, s[24:27], 0 offen
v_add_u32 v5, 3840, v4
buffer_load_dwordx2 v[16:17], v5, s[24:27], 0 offen
v_add_u32 v5, 5120, v4
buffer_load_dwordx2 v[18:19], v5, s[24:27], 0 offen
v_add_u32 v5, 6400, v4
buffer_load_dwordx2 v[20:21], v5, s[24:27], 0 offen
v_add_u32 v5, 7680, v4
buffer_load_dwordx2 v[22:23], v5, s[24:27], 0 offen
v_add_u32 v5, 8960, v4
buffer_load_dwordx2 v[24:25], v5, s[24:27], 0 offen
v_add_u32 v5, 10240, v4
buffer_load_dwordx2 v[26:27], v5, s[24:27], 0 offen
v_add_u32 v5, 11520, v4
buffer_load_dwordx2 v[28:29], v5, s[24:27], 0 offen
v_add_u32 v5, 12800, v4
buffer_load_dwordx2 v[30:31], v5, s[24:27], 0 offen
s_mov_b32 s18, 0
buffer_load_dwordx2 v[32:33], v3, s[28:31], s18 offen
buffer_load_dwordx2 v[48:49], v3, s[20:23], s18 offen
s_mov_b32 s18, 1280
buffer_load_dwordx2 v[34:35], v3, s[28:31], s18 offen
buffer_load_dwordx2 v[50:51], v3, s[20:23], s18 offen
s_mov_b32 s18, 2560
buffer_load_dwordx2 v[36:37], v3, s[28:31], s18 offen
buffer_load_dwordx2 v[52:53], v3, s[20:23], s18 offen
s_mov_b32 s18, 3840
buffer_load_dwordx2 v[38:39], v3, s[28:31], s18 offen
buffer_load_dwordx2 v[54:55], v3, s[20:23], s18 offen
s_mov_b32 s18, 5120
buffer_load_dwordx2 v[40:41], v3, s[28:31], s18 offen
buffer_load_dwordx2 v[56:57], v3, s[20:23], s18 offen
s_mov_b32 s18, 6400
buffer_load_dwordx2 v[42:43], v3, s[28:31], s18 offen
buffer_load_dwordx2 v[58:59], v3, s[20:23], s18 offen
s_mov_b32 s18, 7680
buffer_load_dwordx2 v[44:45], v3, s[28:31], s18 offen
buffer_load_dwordx2 v[60:61], v3, s[20:23], s18 offen
s_mov_b32 s18, 8960
buffer_load_dwordx2 v[46:47], v3, s[28:31], s18 offen
buffer_load_dwordx2 v[62:63], v3, s[20:23], s18 offen
v_lshlrev_b32 v5, 1, v2
buffer_load_ushort v128, v5, s[36:39], 0 offen offset:0
buffer_load_ushort v129, v5, s[36:39], 0 offen offset:128
buffer_load_ushort v130, v5, s[36:39], 0 offen offset:256
buffer_load_ushort v131, v5, s[36:39], 0 offen offset:384
buffer_load_ushort v132, v5, s[36:39], 0 offen offset:512
buffer_load_ushort v133, v5, s[36:39], 0 offen offset:640
buffer_load_ushort v134, v5, s[36:39], 0 offen offset:768
buffer_load_ushort v135, v5, s[36:39], 0 offen offset:896
buffer_load_ushort v136, v5, s[36:39], 0 offen offset:1024
buffer_load_ushort v137, v5, s[36:39], 0 offen offset:1152
buffer_load_ushort v138, v5, s[36:39], 0 offen offset:1280
buffer_load_ushort v139, v5, s[36:39], 0 offen offset:1408
buffer_load_ushort v140, v5, s[36:39], 0 offen offset:1536
buffer_load_ushort v141, v5, s[36:39], 0 offen offset:1664
buffer_load_ushort v142, v5, s[36:39], 0 offen offset:1792
buffer_load_ushort v143, v5, s[36:39], 0 offen offset:1920
buffer_load_ushort v144, v5, s[36:39], 0 offen offset:2048
buffer_load_ushort v145, v5, s[36:39], 0 offen offset:2176
buffer_load_ushort v146, v5, s[36:39], 0 offen offset:2304
buffer_load_ushort v147, v5, s[36:39], 0 offen offset:2432
buffer_load_ushort v148, v5, s[36:39], 0 offen offset:2560
buffer_load_ushort v149, v5, s[36:39], 0 offen offset:2688
buffer_load_ushort v150, v5, s[36:39], 0 offen offset:2816
buffer_load_ushort v151, v5, s[36:39], 0 offen offset:2944
buffer_load_ushort v152, v5, s[36:39], 0 offen offset:3072
buffer_load_ushort v153, v5, s[36:39], 0 offen offset:3200
buffer_load_ushort v154, v5, s[36:39], 0 offen offset:3328
buffer_load_ushort v155, v5, s[36:39], 0 offen offset:3456
buffer_load_ushort v156, v5, s[36:39], 0 offen offset:3584
buffer_load_ushort v157, v5, s[36:39], 0 offen offset:3712
buffer_load_ushort v158, v5, s[36:39], 0 offen offset:3840
buffer_load_ushort v159, v5, s[36:39], 0 offen offset:3968
s_waitcnt vmcnt(32)
v_lshlrev_b32 v7, 16, v10
v_mul_f32 v7, s55, v7
v_cvt_pk_bf16_f32 v9, v7, v7
v_lshlrev_b32 v7, 16, v9
v_mov_b32 v6, v7
v_lshlrev_b32 v7, 16, v12
v_mul_f32 v7, s54, v7
v_cvt_pk_bf16_f32 v9, v7, v7
v_lshlrev_b32 v7, 16, v9
v_add_f32 v6, v6, v7
v_cvt_pk_bf16_f32 v9, v6, v6
v_lshlrev_b32 v6, 16, v9
v_lshlrev_b32 v7, 16, v14
v_mul_f32 v7, s53, v7
v_cvt_pk_bf16_f32 v9, v7, v7
v_lshlrev_b32 v7, 16, v9
v_add_f32 v6, v6, v7
v_cvt_pk_bf16_f32 v9, v6, v6
v_lshlrev_b32 v6, 16, v9
v_lshlrev_b32 v7, 16, v16
v_mul_f32 v7, s52, v7
v_cvt_pk_bf16_f32 v9, v7, v7
v_lshlrev_b32 v7, 16, v9
v_add_f32 v6, v6, v7
v_cvt_pk_bf16_f32 v9, v6, v6
v_lshlrev_b32 v6, 16, v9
v_lshlrev_b32 v7, 16, v32
v_mul_f32 v6, v6, v7
v_cvt_pk_bf16_f32 v9, v6, v6
v_lshlrev_b32 v6, 16, v9
v_mul_f32 v64, s68, v6
v_cvt_pk_bf16_f32 v9, v64, v64
v_lshlrev_b32 v64, 16, v9
v_lshrrev_b32 v96, 16, v6
v_and_b32 v7, 0xffff0000, v10
v_mul_f32 v7, s59, v7
v_cvt_pk_bf16_f32 v9, v7, v7
v_lshlrev_b32 v7, 16, v9
v_mov_b32 v6, v7
v_and_b32 v7, 0xffff0000, v12
v_mul_f32 v7, s58, v7
v_cvt_pk_bf16_f32 v9, v7, v7
v_lshlrev_b32 v7, 16, v9
v_add_f32 v6, v6, v7
v_cvt_pk_bf16_f32 v9, v6, v6
v_lshlrev_b32 v6, 16, v9
v_and_b32 v7, 0xffff0000, v14
v_mul_f32 v7, s57, v7
v_cvt_pk_bf16_f32 v9, v7, v7
v_lshlrev_b32 v7, 16, v9
v_add_f32 v6, v6, v7
v_cvt_pk_bf16_f32 v9, v6, v6
v_lshlrev_b32 v6, 16, v9
v_and_b32 v7, 0xffff0000, v16
v_mul_f32 v7, s56, v7
v_cvt_pk_bf16_f32 v9, v7, v7
v_lshlrev_b32 v7, 16, v9
v_add_f32 v6, v6, v7
v_cvt_pk_bf16_f32 v9, v6, v6
v_lshlrev_b32 v6, 16, v9
v_and_b32 v7, 0xffff0000, v32
v_mul_f32 v6, v6, v7
v_cvt_pk_bf16_f32 v9, v6, v6
v_lshlrev_b32 v6, 16, v9
v_mul_f32 v65, s69, v6
v_cvt_pk_bf16_f32 v9, v65, v65
v_lshlrev_b32 v65, 16, v9
v_lshrrev_b32 v100, 16, v6
v_lshlrev_b32 v7, 16, v11
v_mul_f32 v7, s63, v7
v_cvt_pk_bf16_f32 v9, v7, v7
v_lshlrev_b32 v7, 16, v9
v_mov_b32 v6, v7
v_lshlrev_b32 v7, 16, v13
v_mul_f32 v7, s62, v7
v_cvt_pk_bf16_f32 v9, v7, v7
v_lshlrev_b32 v7, 16, v9
v_add_f32 v6, v6, v7
v_cvt_pk_bf16_f32 v9, v6, v6
v_lshlrev_b32 v6, 16, v9
v_lshlrev_b32 v7, 16, v15
v_mul_f32 v7, s61, v7
v_cvt_pk_bf16_f32 v9, v7, v7
v_lshlrev_b32 v7, 16, v9
v_add_f32 v6, v6, v7
v_cvt_pk_bf16_f32 v9, v6, v6
v_lshlrev_b32 v6, 16, v9
v_lshlrev_b32 v7, 16, v17
v_mul_f32 v7, s60, v7
v_cvt_pk_bf16_f32 v9, v7, v7
v_lshlrev_b32 v7, 16, v9
v_add_f32 v6, v6, v7
v_cvt_pk_bf16_f32 v9, v6, v6
v_lshlrev_b32 v6, 16, v9
v_lshlrev_b32 v7, 16, v33
v_mul_f32 v6, v6, v7
v_cvt_pk_bf16_f32 v9, v6, v6
v_lshlrev_b32 v6, 16, v9
v_mul_f32 v66, s70, v6
v_cvt_pk_bf16_f32 v9, v66, v66
v_lshlrev_b32 v66, 16, v9
v_lshrrev_b32 v104, 16, v6
v_and_b32 v7, 0xffff0000, v11
v_mul_f32 v7, s67, v7
v_cvt_pk_bf16_f32 v9, v7, v7
v_lshlrev_b32 v7, 16, v9
v_mov_b32 v6, v7
v_and_b32 v7, 0xffff0000, v13
v_mul_f32 v7, s66, v7
v_cvt_pk_bf16_f32 v9, v7, v7
v_lshlrev_b32 v7, 16, v9
v_add_f32 v6, v6, v7
v_cvt_pk_bf16_f32 v9, v6, v6
v_lshlrev_b32 v6, 16, v9
v_and_b32 v7, 0xffff0000, v15
v_mul_f32 v7, s65, v7
v_cvt_pk_bf16_f32 v9, v7, v7
v_lshlrev_b32 v7, 16, v9
v_add_f32 v6, v6, v7
v_cvt_pk_bf16_f32 v9, v6, v6
v_lshlrev_b32 v6, 16, v9
v_and_b32 v7, 0xffff0000, v17
v_mul_f32 v7, s64, v7
v_cvt_pk_bf16_f32 v9, v7, v7
v_lshlrev_b32 v7, 16, v9
v_add_f32 v6, v6, v7
v_cvt_pk_bf16_f32 v9, v6, v6
v_lshlrev_b32 v6, 16, v9
v_and_b32 v7, 0xffff0000, v33
v_mul_f32 v6, v6, v7
v_cvt_pk_bf16_f32 v9, v6, v6
v_lshlrev_b32 v6, 16, v9
v_mul_f32 v67, s71, v6
v_cvt_pk_bf16_f32 v9, v67, v67
v_lshlrev_b32 v67, 16, v9
v_lshrrev_b32 v108, 16, v6
v_lshlrev_b32 v7, 16, v12
v_mul_f32 v7, s55, v7
v_cvt_pk_bf16_f32 v9, v7, v7
v_lshlrev_b32 v7, 16, v9
v_mov_b32 v6, v7
v_lshlrev_b32 v7, 16, v14
v_mul_f32 v7, s54, v7
v_cvt_pk_bf16_f32 v9, v7, v7
v_lshlrev_b32 v7, 16, v9
v_add_f32 v6, v6, v7
v_cvt_pk_bf16_f32 v9, v6, v6
v_lshlrev_b32 v6, 16, v9
v_lshlrev_b32 v7, 16, v16
v_mul_f32 v7, s53, v7
v_cvt_pk_bf16_f32 v9, v7, v7
v_lshlrev_b32 v7, 16, v9
v_add_f32 v6, v6, v7
v_cvt_pk_bf16_f32 v9, v6, v6
v_lshlrev_b32 v6, 16, v9
v_lshlrev_b32 v7, 16, v18
v_mul_f32 v7, s52, v7
v_cvt_pk_bf16_f32 v9, v7, v7
v_lshlrev_b32 v7, 16, v9
v_add_f32 v6, v6, v7
v_cvt_pk_bf16_f32 v9, v6, v6
v_lshlrev_b32 v6, 16, v9
v_lshlrev_b32 v7, 16, v34
v_mul_f32 v6, v6, v7
v_cvt_pk_bf16_f32 v9, v6, v6
v_lshlrev_b32 v6, 16, v9
v_mul_f32 v68, s68, v6
v_cvt_pk_bf16_f32 v9, v68, v68
v_lshlrev_b32 v68, 16, v9
v_or_b32 v96, v96, v6
v_and_b32 v7, 0xffff0000, v12
v_mul_f32 v7, s59, v7
v_cvt_pk_bf16_f32 v9, v7, v7
v_lshlrev_b32 v7, 16, v9
v_mov_b32 v6, v7
v_and_b32 v7, 0xffff0000, v14
v_mul_f32 v7, s58, v7
v_cvt_pk_bf16_f32 v9, v7, v7
v_lshlrev_b32 v7, 16, v9
v_add_f32 v6, v6, v7
v_cvt_pk_bf16_f32 v9, v6, v6
v_lshlrev_b32 v6, 16, v9
v_and_b32 v7, 0xffff0000, v16
v_mul_f32 v7, s57, v7
v_cvt_pk_bf16_f32 v9, v7, v7
v_lshlrev_b32 v7, 16, v9
v_add_f32 v6, v6, v7
v_cvt_pk_bf16_f32 v9, v6, v6
v_lshlrev_b32 v6, 16, v9
v_and_b32 v7, 0xffff0000, v18
v_mul_f32 v7, s56, v7
v_cvt_pk_bf16_f32 v9, v7, v7
v_lshlrev_b32 v7, 16, v9
v_add_f32 v6, v6, v7
v_cvt_pk_bf16_f32 v9, v6, v6
v_lshlrev_b32 v6, 16, v9
v_and_b32 v7, 0xffff0000, v34
v_mul_f32 v6, v6, v7
v_cvt_pk_bf16_f32 v9, v6, v6
v_lshlrev_b32 v6, 16, v9
v_mul_f32 v69, s69, v6
v_cvt_pk_bf16_f32 v9, v69, v69
v_lshlrev_b32 v69, 16, v9
v_or_b32 v100, v100, v6
v_lshlrev_b32 v7, 16, v13
v_mul_f32 v7, s63, v7
v_cvt_pk_bf16_f32 v9, v7, v7
v_lshlrev_b32 v7, 16, v9
v_mov_b32 v6, v7
v_lshlrev_b32 v7, 16, v15
v_mul_f32 v7, s62, v7
v_cvt_pk_bf16_f32 v9, v7, v7
v_lshlrev_b32 v7, 16, v9
v_add_f32 v6, v6, v7
v_cvt_pk_bf16_f32 v9, v6, v6
v_lshlrev_b32 v6, 16, v9
v_lshlrev_b32 v7, 16, v17
v_mul_f32 v7, s61, v7
v_cvt_pk_bf16_f32 v9, v7, v7
v_lshlrev_b32 v7, 16, v9
v_add_f32 v6, v6, v7
v_cvt_pk_bf16_f32 v9, v6, v6
v_lshlrev_b32 v6, 16, v9
v_lshlrev_b32 v7, 16, v19
v_mul_f32 v7, s60, v7
v_cvt_pk_bf16_f32 v9, v7, v7
v_lshlrev_b32 v7, 16, v9
v_add_f32 v6, v6, v7
v_cvt_pk_bf16_f32 v9, v6, v6
v_lshlrev_b32 v6, 16, v9
v_lshlrev_b32 v7, 16, v35
v_mul_f32 v6, v6, v7
v_cvt_pk_bf16_f32 v9, v6, v6
v_lshlrev_b32 v6, 16, v9
v_mul_f32 v70, s70, v6
v_cvt_pk_bf16_f32 v9, v70, v70
v_lshlrev_b32 v70, 16, v9
v_or_b32 v104, v104, v6
v_and_b32 v7, 0xffff0000, v13
v_mul_f32 v7, s67, v7
v_cvt_pk_bf16_f32 v9, v7, v7
v_lshlrev_b32 v7, 16, v9
v_mov_b32 v6, v7
v_and_b32 v7, 0xffff0000, v15
v_mul_f32 v7, s66, v7
v_cvt_pk_bf16_f32 v9, v7, v7
v_lshlrev_b32 v7, 16, v9
v_add_f32 v6, v6, v7
v_cvt_pk_bf16_f32 v9, v6, v6
v_lshlrev_b32 v6, 16, v9
v_and_b32 v7, 0xffff0000, v17
v_mul_f32 v7, s65, v7
v_cvt_pk_bf16_f32 v9, v7, v7
v_lshlrev_b32 v7, 16, v9
v_add_f32 v6, v6, v7
v_cvt_pk_bf16_f32 v9, v6, v6
v_lshlrev_b32 v6, 16, v9
v_and_b32 v7, 0xffff0000, v19
v_mul_f32 v7, s64, v7
v_cvt_pk_bf16_f32 v9, v7, v7
v_lshlrev_b32 v7, 16, v9
v_add_f32 v6, v6, v7
v_cvt_pk_bf16_f32 v9, v6, v6
v_lshlrev_b32 v6, 16, v9
v_and_b32 v7, 0xffff0000, v35
v_mul_f32 v6, v6, v7
v_cvt_pk_bf16_f32 v9, v6, v6
v_lshlrev_b32 v6, 16, v9
v_mul_f32 v71, s71, v6
v_cvt_pk_bf16_f32 v9, v71, v71
v_lshlrev_b32 v71, 16, v9
v_or_b32 v108, v108, v6
v_lshlrev_b32 v7, 16, v14
v_mul_f32 v7, s55, v7
v_cvt_pk_bf16_f32 v9, v7, v7
v_lshlrev_b32 v7, 16, v9
v_mov_b32 v6, v7
v_lshlrev_b32 v7, 16, v16
v_mul_f32 v7, s54, v7
v_cvt_pk_bf16_f32 v9, v7, v7
v_lshlrev_b32 v7, 16, v9
v_add_f32 v6, v6, v7
v_cvt_pk_bf16_f32 v9, v6, v6
v_lshlrev_b32 v6, 16, v9
v_lshlrev_b32 v7, 16, v18
v_mul_f32 v7, s53, v7
v_cvt_pk_bf16_f32 v9, v7, v7
v_lshlrev_b32 v7, 16, v9
v_add_f32 v6, v6, v7
v_cvt_pk_bf16_f32 v9, v6, v6
v_lshlrev_b32 v6, 16, v9
v_lshlrev_b32 v7, 16, v20
v_mul_f32 v7, s52, v7
v_cvt_pk_bf16_f32 v9, v7, v7
v_lshlrev_b32 v7, 16, v9
v_add_f32 v6, v6, v7
v_cvt_pk_bf16_f32 v9, v6, v6
v_lshlrev_b32 v6, 16, v9
v_lshlrev_b32 v7, 16, v36
v_mul_f32 v6, v6, v7
v_cvt_pk_bf16_f32 v9, v6, v6
v_lshlrev_b32 v6, 16, v9
v_mul_f32 v72, s68, v6
v_cvt_pk_bf16_f32 v9, v72, v72
v_lshlrev_b32 v72, 16, v9
v_lshrrev_b32 v97, 16, v6
v_and_b32 v7, 0xffff0000, v14
v_mul_f32 v7, s59, v7
v_cvt_pk_bf16_f32 v9, v7, v7
v_lshlrev_b32 v7, 16, v9
v_mov_b32 v6, v7
v_and_b32 v7, 0xffff0000, v16
v_mul_f32 v7, s58, v7
v_cvt_pk_bf16_f32 v9, v7, v7
v_lshlrev_b32 v7, 16, v9
v_add_f32 v6, v6, v7
v_cvt_pk_bf16_f32 v9, v6, v6
v_lshlrev_b32 v6, 16, v9
v_and_b32 v7, 0xffff0000, v18
v_mul_f32 v7, s57, v7
v_cvt_pk_bf16_f32 v9, v7, v7
v_lshlrev_b32 v7, 16, v9
v_add_f32 v6, v6, v7
v_cvt_pk_bf16_f32 v9, v6, v6
v_lshlrev_b32 v6, 16, v9
v_and_b32 v7, 0xffff0000, v20
v_mul_f32 v7, s56, v7
v_cvt_pk_bf16_f32 v9, v7, v7
v_lshlrev_b32 v7, 16, v9
v_add_f32 v6, v6, v7
v_cvt_pk_bf16_f32 v9, v6, v6
v_lshlrev_b32 v6, 16, v9
v_and_b32 v7, 0xffff0000, v36
v_mul_f32 v6, v6, v7
v_cvt_pk_bf16_f32 v9, v6, v6
v_lshlrev_b32 v6, 16, v9
v_mul_f32 v73, s69, v6
v_cvt_pk_bf16_f32 v9, v73, v73
v_lshlrev_b32 v73, 16, v9
v_lshrrev_b32 v101, 16, v6
v_lshlrev_b32 v7, 16, v15
v_mul_f32 v7, s63, v7
v_cvt_pk_bf16_f32 v9, v7, v7
v_lshlrev_b32 v7, 16, v9
v_mov_b32 v6, v7
v_lshlrev_b32 v7, 16, v17
v_mul_f32 v7, s62, v7
v_cvt_pk_bf16_f32 v9, v7, v7
v_lshlrev_b32 v7, 16, v9
v_add_f32 v6, v6, v7
v_cvt_pk_bf16_f32 v9, v6, v6
v_lshlrev_b32 v6, 16, v9
v_lshlrev_b32 v7, 16, v19
v_mul_f32 v7, s61, v7
v_cvt_pk_bf16_f32 v9, v7, v7
v_lshlrev_b32 v7, 16, v9
v_add_f32 v6, v6, v7
v_cvt_pk_bf16_f32 v9, v6, v6
v_lshlrev_b32 v6, 16, v9
v_lshlrev_b32 v7, 16, v21
v_mul_f32 v7, s60, v7
v_cvt_pk_bf16_f32 v9, v7, v7
v_lshlrev_b32 v7, 16, v9
v_add_f32 v6, v6, v7
v_cvt_pk_bf16_f32 v9, v6, v6
v_lshlrev_b32 v6, 16, v9
v_lshlrev_b32 v7, 16, v37
v_mul_f32 v6, v6, v7
v_cvt_pk_bf16_f32 v9, v6, v6
v_lshlrev_b32 v6, 16, v9
v_mul_f32 v74, s70, v6
v_cvt_pk_bf16_f32 v9, v74, v74
v_lshlrev_b32 v74, 16, v9
v_lshrrev_b32 v105, 16, v6
v_and_b32 v7, 0xffff0000, v15
v_mul_f32 v7, s67, v7
v_cvt_pk_bf16_f32 v9, v7, v7
v_lshlrev_b32 v7, 16, v9
v_mov_b32 v6, v7
v_and_b32 v7, 0xffff0000, v17
v_mul_f32 v7, s66, v7
v_cvt_pk_bf16_f32 v9, v7, v7
v_lshlrev_b32 v7, 16, v9
v_add_f32 v6, v6, v7
v_cvt_pk_bf16_f32 v9, v6, v6
v_lshlrev_b32 v6, 16, v9
v_and_b32 v7, 0xffff0000, v19
v_mul_f32 v7, s65, v7
v_cvt_pk_bf16_f32 v9, v7, v7
v_lshlrev_b32 v7, 16, v9
v_add_f32 v6, v6, v7
v_cvt_pk_bf16_f32 v9, v6, v6
v_lshlrev_b32 v6, 16, v9
v_and_b32 v7, 0xffff0000, v21
v_mul_f32 v7, s64, v7
v_cvt_pk_bf16_f32 v9, v7, v7
v_lshlrev_b32 v7, 16, v9
v_add_f32 v6, v6, v7
v_cvt_pk_bf16_f32 v9, v6, v6
v_lshlrev_b32 v6, 16, v9
v_and_b32 v7, 0xffff0000, v37
v_mul_f32 v6, v6, v7
v_cvt_pk_bf16_f32 v9, v6, v6
v_lshlrev_b32 v6, 16, v9
v_mul_f32 v75, s71, v6
v_cvt_pk_bf16_f32 v9, v75, v75
v_lshlrev_b32 v75, 16, v9
v_lshrrev_b32 v109, 16, v6
v_lshlrev_b32 v7, 16, v16
v_mul_f32 v7, s55, v7
v_cvt_pk_bf16_f32 v9, v7, v7
v_lshlrev_b32 v7, 16, v9
v_mov_b32 v6, v7
v_lshlrev_b32 v7, 16, v18
v_mul_f32 v7, s54, v7
v_cvt_pk_bf16_f32 v9, v7, v7
v_lshlrev_b32 v7, 16, v9
v_add_f32 v6, v6, v7
v_cvt_pk_bf16_f32 v9, v6, v6
v_lshlrev_b32 v6, 16, v9
v_lshlrev_b32 v7, 16, v20
v_mul_f32 v7, s53, v7
v_cvt_pk_bf16_f32 v9, v7, v7
v_lshlrev_b32 v7, 16, v9
v_add_f32 v6, v6, v7
v_cvt_pk_bf16_f32 v9, v6, v6
v_lshlrev_b32 v6, 16, v9
v_lshlrev_b32 v7, 16, v22
v_mul_f32 v7, s52, v7
v_cvt_pk_bf16_f32 v9, v7, v7
v_lshlrev_b32 v7, 16, v9
v_add_f32 v6, v6, v7
v_cvt_pk_bf16_f32 v9, v6, v6
v_lshlrev_b32 v6, 16, v9
v_lshlrev_b32 v7, 16, v38
v_mul_f32 v6, v6, v7
v_cvt_pk_bf16_f32 v9, v6, v6
v_lshlrev_b32 v6, 16, v9
v_mul_f32 v76, s68, v6
v_cvt_pk_bf16_f32 v9, v76, v76
v_lshlrev_b32 v76, 16, v9
v_or_b32 v97, v97, v6
v_and_b32 v7, 0xffff0000, v16
v_mul_f32 v7, s59, v7
v_cvt_pk_bf16_f32 v9, v7, v7
v_lshlrev_b32 v7, 16, v9
v_mov_b32 v6, v7
v_and_b32 v7, 0xffff0000, v18
v_mul_f32 v7, s58, v7
v_cvt_pk_bf16_f32 v9, v7, v7
v_lshlrev_b32 v7, 16, v9
v_add_f32 v6, v6, v7
v_cvt_pk_bf16_f32 v9, v6, v6
v_lshlrev_b32 v6, 16, v9
v_and_b32 v7, 0xffff0000, v20
v_mul_f32 v7, s57, v7
v_cvt_pk_bf16_f32 v9, v7, v7
v_lshlrev_b32 v7, 16, v9
v_add_f32 v6, v6, v7
v_cvt_pk_bf16_f32 v9, v6, v6
v_lshlrev_b32 v6, 16, v9
v_and_b32 v7, 0xffff0000, v22
v_mul_f32 v7, s56, v7
v_cvt_pk_bf16_f32 v9, v7, v7
v_lshlrev_b32 v7, 16, v9
v_add_f32 v6, v6, v7
v_cvt_pk_bf16_f32 v9, v6, v6
v_lshlrev_b32 v6, 16, v9
v_and_b32 v7, 0xffff0000, v38
v_mul_f32 v6, v6, v7
v_cvt_pk_bf16_f32 v9, v6, v6
v_lshlrev_b32 v6, 16, v9
v_mul_f32 v77, s69, v6
v_cvt_pk_bf16_f32 v9, v77, v77
v_lshlrev_b32 v77, 16, v9
v_or_b32 v101, v101, v6
v_lshlrev_b32 v7, 16, v17
v_mul_f32 v7, s63, v7
v_cvt_pk_bf16_f32 v9, v7, v7
v_lshlrev_b32 v7, 16, v9
v_mov_b32 v6, v7
v_lshlrev_b32 v7, 16, v19
v_mul_f32 v7, s62, v7
v_cvt_pk_bf16_f32 v9, v7, v7
v_lshlrev_b32 v7, 16, v9
v_add_f32 v6, v6, v7
v_cvt_pk_bf16_f32 v9, v6, v6
v_lshlrev_b32 v6, 16, v9
v_lshlrev_b32 v7, 16, v21
v_mul_f32 v7, s61, v7
v_cvt_pk_bf16_f32 v9, v7, v7
v_lshlrev_b32 v7, 16, v9
v_add_f32 v6, v6, v7
v_cvt_pk_bf16_f32 v9, v6, v6
v_lshlrev_b32 v6, 16, v9
v_lshlrev_b32 v7, 16, v23
v_mul_f32 v7, s60, v7
v_cvt_pk_bf16_f32 v9, v7, v7
v_lshlrev_b32 v7, 16, v9
v_add_f32 v6, v6, v7
v_cvt_pk_bf16_f32 v9, v6, v6
v_lshlrev_b32 v6, 16, v9
v_lshlrev_b32 v7, 16, v39
v_mul_f32 v6, v6, v7
v_cvt_pk_bf16_f32 v9, v6, v6
v_lshlrev_b32 v6, 16, v9
v_mul_f32 v78, s70, v6
v_cvt_pk_bf16_f32 v9, v78, v78
v_lshlrev_b32 v78, 16, v9
v_or_b32 v105, v105, v6
v_and_b32 v7, 0xffff0000, v17
v_mul_f32 v7, s67, v7
v_cvt_pk_bf16_f32 v9, v7, v7
v_lshlrev_b32 v7, 16, v9
v_mov_b32 v6, v7
v_and_b32 v7, 0xffff0000, v19
v_mul_f32 v7, s66, v7
v_cvt_pk_bf16_f32 v9, v7, v7
v_lshlrev_b32 v7, 16, v9
v_add_f32 v6, v6, v7
v_cvt_pk_bf16_f32 v9, v6, v6
v_lshlrev_b32 v6, 16, v9
v_and_b32 v7, 0xffff0000, v21
v_mul_f32 v7, s65, v7
v_cvt_pk_bf16_f32 v9, v7, v7
v_lshlrev_b32 v7, 16, v9
v_add_f32 v6, v6, v7
v_cvt_pk_bf16_f32 v9, v6, v6
v_lshlrev_b32 v6, 16, v9
v_and_b32 v7, 0xffff0000, v23
v_mul_f32 v7, s64, v7
v_cvt_pk_bf16_f32 v9, v7, v7
v_lshlrev_b32 v7, 16, v9
v_add_f32 v6, v6, v7
v_cvt_pk_bf16_f32 v9, v6, v6
v_lshlrev_b32 v6, 16, v9
v_and_b32 v7, 0xffff0000, v39
v_mul_f32 v6, v6, v7
v_cvt_pk_bf16_f32 v9, v6, v6
v_lshlrev_b32 v6, 16, v9
v_mul_f32 v79, s71, v6
v_cvt_pk_bf16_f32 v9, v79, v79
v_lshlrev_b32 v79, 16, v9
v_or_b32 v109, v109, v6
v_lshlrev_b32 v7, 16, v18
v_mul_f32 v7, s55, v7
v_cvt_pk_bf16_f32 v9, v7, v7
v_lshlrev_b32 v7, 16, v9
v_mov_b32 v6, v7
v_lshlrev_b32 v7, 16, v20
v_mul_f32 v7, s54, v7
v_cvt_pk_bf16_f32 v9, v7, v7
v_lshlrev_b32 v7, 16, v9
v_add_f32 v6, v6, v7
v_cvt_pk_bf16_f32 v9, v6, v6
v_lshlrev_b32 v6, 16, v9
v_lshlrev_b32 v7, 16, v22
v_mul_f32 v7, s53, v7
v_cvt_pk_bf16_f32 v9, v7, v7
v_lshlrev_b32 v7, 16, v9
v_add_f32 v6, v6, v7
v_cvt_pk_bf16_f32 v9, v6, v6
v_lshlrev_b32 v6, 16, v9
v_lshlrev_b32 v7, 16, v24
v_mul_f32 v7, s52, v7
v_cvt_pk_bf16_f32 v9, v7, v7
v_lshlrev_b32 v7, 16, v9
v_add_f32 v6, v6, v7
v_cvt_pk_bf16_f32 v9, v6, v6
v_lshlrev_b32 v6, 16, v9
v_lshlrev_b32 v7, 16, v40
v_mul_f32 v6, v6, v7
v_cvt_pk_bf16_f32 v9, v6, v6
v_lshlrev_b32 v6, 16, v9
v_mul_f32 v80, s68, v6
v_cvt_pk_bf16_f32 v9, v80, v80
v_lshlrev_b32 v80, 16, v9
v_lshrrev_b32 v98, 16, v6
v_and_b32 v7, 0xffff0000, v18
v_mul_f32 v7, s59, v7
v_cvt_pk_bf16_f32 v9, v7, v7
v_lshlrev_b32 v7, 16, v9
v_mov_b32 v6, v7
v_and_b32 v7, 0xffff0000, v20
v_mul_f32 v7, s58, v7
v_cvt_pk_bf16_f32 v9, v7, v7
v_lshlrev_b32 v7, 16, v9
v_add_f32 v6, v6, v7
v_cvt_pk_bf16_f32 v9, v6, v6
v_lshlrev_b32 v6, 16, v9
v_and_b32 v7, 0xffff0000, v22
v_mul_f32 v7, s57, v7
v_cvt_pk_bf16_f32 v9, v7, v7
v_lshlrev_b32 v7, 16, v9
v_add_f32 v6, v6, v7
v_cvt_pk_bf16_f32 v9, v6, v6
v_lshlrev_b32 v6, 16, v9
v_and_b32 v7, 0xffff0000, v24
v_mul_f32 v7, s56, v7
v_cvt_pk_bf16_f32 v9, v7, v7
v_lshlrev_b32 v7, 16, v9
v_add_f32 v6, v6, v7
v_cvt_pk_bf16_f32 v9, v6, v6
v_lshlrev_b32 v6, 16, v9
v_and_b32 v7, 0xffff0000, v40
v_mul_f32 v6, v6, v7
v_cvt_pk_bf16_f32 v9, v6, v6
v_lshlrev_b32 v6, 16, v9
v_mul_f32 v81, s69, v6
v_cvt_pk_bf16_f32 v9, v81, v81
v_lshlrev_b32 v81, 16, v9
v_lshrrev_b32 v102, 16, v6
v_lshlrev_b32 v7, 16, v19
v_mul_f32 v7, s63, v7
v_cvt_pk_bf16_f32 v9, v7, v7
v_lshlrev_b32 v7, 16, v9
v_mov_b32 v6, v7
v_lshlrev_b32 v7, 16, v21
v_mul_f32 v7, s62, v7
v_cvt_pk_bf16_f32 v9, v7, v7
v_lshlrev_b32 v7, 16, v9
v_add_f32 v6, v6, v7
v_cvt_pk_bf16_f32 v9, v6, v6
v_lshlrev_b32 v6, 16, v9
v_lshlrev_b32 v7, 16, v23
v_mul_f32 v7, s61, v7
v_cvt_pk_bf16_f32 v9, v7, v7
v_lshlrev_b32 v7, 16, v9
v_add_f32 v6, v6, v7
v_cvt_pk_bf16_f32 v9, v6, v6
v_lshlrev_b32 v6, 16, v9
v_lshlrev_b32 v7, 16, v25
v_mul_f32 v7, s60, v7
v_cvt_pk_bf16_f32 v9, v7, v7
v_lshlrev_b32 v7, 16, v9
v_add_f32 v6, v6, v7
v_cvt_pk_bf16_f32 v9, v6, v6
v_lshlrev_b32 v6, 16, v9
v_lshlrev_b32 v7, 16, v41
v_mul_f32 v6, v6, v7
v_cvt_pk_bf16_f32 v9, v6, v6
v_lshlrev_b32 v6, 16, v9
v_mul_f32 v82, s70, v6
v_cvt_pk_bf16_f32 v9, v82, v82
v_lshlrev_b32 v82, 16, v9
v_lshrrev_b32 v106, 16, v6
v_and_b32 v7, 0xffff0000, v19
v_mul_f32 v7, s67, v7
v_cvt_pk_bf16_f32 v9, v7, v7
v_lshlrev_b32 v7, 16, v9
v_mov_b32 v6, v7
v_and_b32 v7, 0xffff0000, v21
v_mul_f32 v7, s66, v7
v_cvt_pk_bf16_f32 v9, v7, v7
v_lshlrev_b32 v7, 16, v9
v_add_f32 v6, v6, v7
v_cvt_pk_bf16_f32 v9, v6, v6
v_lshlrev_b32 v6, 16, v9
v_and_b32 v7, 0xffff0000, v23
v_mul_f32 v7, s65, v7
v_cvt_pk_bf16_f32 v9, v7, v7
v_lshlrev_b32 v7, 16, v9
v_add_f32 v6, v6, v7
v_cvt_pk_bf16_f32 v9, v6, v6
v_lshlrev_b32 v6, 16, v9
v_and_b32 v7, 0xffff0000, v25
v_mul_f32 v7, s64, v7
v_cvt_pk_bf16_f32 v9, v7, v7
v_lshlrev_b32 v7, 16, v9
v_add_f32 v6, v6, v7
v_cvt_pk_bf16_f32 v9, v6, v6
v_lshlrev_b32 v6, 16, v9
v_and_b32 v7, 0xffff0000, v41
v_mul_f32 v6, v6, v7
v_cvt_pk_bf16_f32 v9, v6, v6
v_lshlrev_b32 v6, 16, v9
v_mul_f32 v83, s71, v6
v_cvt_pk_bf16_f32 v9, v83, v83
v_lshlrev_b32 v83, 16, v9
v_lshrrev_b32 v110, 16, v6
v_lshlrev_b32 v7, 16, v20
v_mul_f32 v7, s55, v7
v_cvt_pk_bf16_f32 v9, v7, v7
v_lshlrev_b32 v7, 16, v9
v_mov_b32 v6, v7
v_lshlrev_b32 v7, 16, v22
v_mul_f32 v7, s54, v7
v_cvt_pk_bf16_f32 v9, v7, v7
v_lshlrev_b32 v7, 16, v9
v_add_f32 v6, v6, v7
v_cvt_pk_bf16_f32 v9, v6, v6
v_lshlrev_b32 v6, 16, v9
v_lshlrev_b32 v7, 16, v24
v_mul_f32 v7, s53, v7
v_cvt_pk_bf16_f32 v9, v7, v7
v_lshlrev_b32 v7, 16, v9
v_add_f32 v6, v6, v7
v_cvt_pk_bf16_f32 v9, v6, v6
v_lshlrev_b32 v6, 16, v9
v_lshlrev_b32 v7, 16, v26
v_mul_f32 v7, s52, v7
v_cvt_pk_bf16_f32 v9, v7, v7
v_lshlrev_b32 v7, 16, v9
v_add_f32 v6, v6, v7
v_cvt_pk_bf16_f32 v9, v6, v6
v_lshlrev_b32 v6, 16, v9
v_lshlrev_b32 v7, 16, v42
v_mul_f32 v6, v6, v7
v_cvt_pk_bf16_f32 v9, v6, v6
v_lshlrev_b32 v6, 16, v9
v_mul_f32 v84, s68, v6
v_cvt_pk_bf16_f32 v9, v84, v84
v_lshlrev_b32 v84, 16, v9
v_or_b32 v98, v98, v6
v_and_b32 v7, 0xffff0000, v20
v_mul_f32 v7, s59, v7
v_cvt_pk_bf16_f32 v9, v7, v7
v_lshlrev_b32 v7, 16, v9
v_mov_b32 v6, v7
v_and_b32 v7, 0xffff0000, v22
v_mul_f32 v7, s58, v7
v_cvt_pk_bf16_f32 v9, v7, v7
v_lshlrev_b32 v7, 16, v9
v_add_f32 v6, v6, v7
v_cvt_pk_bf16_f32 v9, v6, v6
v_lshlrev_b32 v6, 16, v9
v_and_b32 v7, 0xffff0000, v24
v_mul_f32 v7, s57, v7
v_cvt_pk_bf16_f32 v9, v7, v7
v_lshlrev_b32 v7, 16, v9
v_add_f32 v6, v6, v7
v_cvt_pk_bf16_f32 v9, v6, v6
v_lshlrev_b32 v6, 16, v9
v_and_b32 v7, 0xffff0000, v26
v_mul_f32 v7, s56, v7
v_cvt_pk_bf16_f32 v9, v7, v7
v_lshlrev_b32 v7, 16, v9
v_add_f32 v6, v6, v7
v_cvt_pk_bf16_f32 v9, v6, v6
v_lshlrev_b32 v6, 16, v9
v_and_b32 v7, 0xffff0000, v42
v_mul_f32 v6, v6, v7
v_cvt_pk_bf16_f32 v9, v6, v6
v_lshlrev_b32 v6, 16, v9
v_mul_f32 v85, s69, v6
v_cvt_pk_bf16_f32 v9, v85, v85
v_lshlrev_b32 v85, 16, v9
v_or_b32 v102, v102, v6
v_lshlrev_b32 v7, 16, v21
v_mul_f32 v7, s63, v7
v_cvt_pk_bf16_f32 v9, v7, v7
v_lshlrev_b32 v7, 16, v9
v_mov_b32 v6, v7
v_lshlrev_b32 v7, 16, v23
v_mul_f32 v7, s62, v7
v_cvt_pk_bf16_f32 v9, v7, v7
v_lshlrev_b32 v7, 16, v9
v_add_f32 v6, v6, v7
v_cvt_pk_bf16_f32 v9, v6, v6
v_lshlrev_b32 v6, 16, v9
v_lshlrev_b32 v7, 16, v25
v_mul_f32 v7, s61, v7
v_cvt_pk_bf16_f32 v9, v7, v7
v_lshlrev_b32 v7, 16, v9
v_add_f32 v6, v6, v7
v_cvt_pk_bf16_f32 v9, v6, v6
v_lshlrev_b32 v6, 16, v9
v_lshlrev_b32 v7, 16, v27
v_mul_f32 v7, s60, v7
v_cvt_pk_bf16_f32 v9, v7, v7
v_lshlrev_b32 v7, 16, v9
v_add_f32 v6, v6, v7
v_cvt_pk_bf16_f32 v9, v6, v6
v_lshlrev_b32 v6, 16, v9
v_lshlrev_b32 v7, 16, v43
v_mul_f32 v6, v6, v7
v_cvt_pk_bf16_f32 v9, v6, v6
v_lshlrev_b32 v6, 16, v9
v_mul_f32 v86, s70, v6
v_cvt_pk_bf16_f32 v9, v86, v86
v_lshlrev_b32 v86, 16, v9
v_or_b32 v106, v106, v6
v_and_b32 v7, 0xffff0000, v21
v_mul_f32 v7, s67, v7
v_cvt_pk_bf16_f32 v9, v7, v7
v_lshlrev_b32 v7, 16, v9
v_mov_b32 v6, v7
v_and_b32 v7, 0xffff0000, v23
v_mul_f32 v7, s66, v7
v_cvt_pk_bf16_f32 v9, v7, v7
v_lshlrev_b32 v7, 16, v9
v_add_f32 v6, v6, v7
v_cvt_pk_bf16_f32 v9, v6, v6
v_lshlrev_b32 v6, 16, v9
v_and_b32 v7, 0xffff0000, v25
v_mul_f32 v7, s65, v7
v_cvt_pk_bf16_f32 v9, v7, v7
v_lshlrev_b32 v7, 16, v9
v_add_f32 v6, v6, v7
v_cvt_pk_bf16_f32 v9, v6, v6
v_lshlrev_b32 v6, 16, v9
v_and_b32 v7, 0xffff0000, v27
v_mul_f32 v7, s64, v7
v_cvt_pk_bf16_f32 v9, v7, v7
v_lshlrev_b32 v7, 16, v9
v_add_f32 v6, v6, v7
v_cvt_pk_bf16_f32 v9, v6, v6
v_lshlrev_b32 v6, 16, v9
v_and_b32 v7, 0xffff0000, v43
v_mul_f32 v6, v6, v7
v_cvt_pk_bf16_f32 v9, v6, v6
v_lshlrev_b32 v6, 16, v9
v_mul_f32 v87, s71, v6
v_cvt_pk_bf16_f32 v9, v87, v87
v_lshlrev_b32 v87, 16, v9
v_or_b32 v110, v110, v6
v_lshlrev_b32 v7, 16, v22
v_mul_f32 v7, s55, v7
v_cvt_pk_bf16_f32 v9, v7, v7
v_lshlrev_b32 v7, 16, v9
v_mov_b32 v6, v7
v_lshlrev_b32 v7, 16, v24
v_mul_f32 v7, s54, v7
v_cvt_pk_bf16_f32 v9, v7, v7
v_lshlrev_b32 v7, 16, v9
v_add_f32 v6, v6, v7
v_cvt_pk_bf16_f32 v9, v6, v6
v_lshlrev_b32 v6, 16, v9
v_lshlrev_b32 v7, 16, v26
v_mul_f32 v7, s53, v7
v_cvt_pk_bf16_f32 v9, v7, v7
v_lshlrev_b32 v7, 16, v9
v_add_f32 v6, v6, v7
v_cvt_pk_bf16_f32 v9, v6, v6
v_lshlrev_b32 v6, 16, v9
v_lshlrev_b32 v7, 16, v28
v_mul_f32 v7, s52, v7
v_cvt_pk_bf16_f32 v9, v7, v7
v_lshlrev_b32 v7, 16, v9
v_add_f32 v6, v6, v7
v_cvt_pk_bf16_f32 v9, v6, v6
v_lshlrev_b32 v6, 16, v9
v_lshlrev_b32 v7, 16, v44
v_mul_f32 v6, v6, v7
v_cvt_pk_bf16_f32 v9, v6, v6
v_lshlrev_b32 v6, 16, v9
v_mul_f32 v88, s68, v6
v_cvt_pk_bf16_f32 v9, v88, v88
v_lshlrev_b32 v88, 16, v9
v_lshrrev_b32 v99, 16, v6
v_and_b32 v7, 0xffff0000, v22
v_mul_f32 v7, s59, v7
v_cvt_pk_bf16_f32 v9, v7, v7
v_lshlrev_b32 v7, 16, v9
v_mov_b32 v6, v7
v_and_b32 v7, 0xffff0000, v24
v_mul_f32 v7, s58, v7
v_cvt_pk_bf16_f32 v9, v7, v7
v_lshlrev_b32 v7, 16, v9
v_add_f32 v6, v6, v7
v_cvt_pk_bf16_f32 v9, v6, v6
v_lshlrev_b32 v6, 16, v9
v_and_b32 v7, 0xffff0000, v26
v_mul_f32 v7, s57, v7
v_cvt_pk_bf16_f32 v9, v7, v7
v_lshlrev_b32 v7, 16, v9
v_add_f32 v6, v6, v7
v_cvt_pk_bf16_f32 v9, v6, v6
v_lshlrev_b32 v6, 16, v9
v_and_b32 v7, 0xffff0000, v28
v_mul_f32 v7, s56, v7
v_cvt_pk_bf16_f32 v9, v7, v7
v_lshlrev_b32 v7, 16, v9
v_add_f32 v6, v6, v7
v_cvt_pk_bf16_f32 v9, v6, v6
v_lshlrev_b32 v6, 16, v9
v_and_b32 v7, 0xffff0000, v44
v_mul_f32 v6, v6, v7
v_cvt_pk_bf16_f32 v9, v6, v6
v_lshlrev_b32 v6, 16, v9
v_mul_f32 v89, s69, v6
v_cvt_pk_bf16_f32 v9, v89, v89
v_lshlrev_b32 v89, 16, v9
v_lshrrev_b32 v103, 16, v6
v_lshlrev_b32 v7, 16, v23
v_mul_f32 v7, s63, v7
v_cvt_pk_bf16_f32 v9, v7, v7
v_lshlrev_b32 v7, 16, v9
v_mov_b32 v6, v7
v_lshlrev_b32 v7, 16, v25
v_mul_f32 v7, s62, v7
v_cvt_pk_bf16_f32 v9, v7, v7
v_lshlrev_b32 v7, 16, v9
v_add_f32 v6, v6, v7
v_cvt_pk_bf16_f32 v9, v6, v6
v_lshlrev_b32 v6, 16, v9
v_lshlrev_b32 v7, 16, v27
v_mul_f32 v7, s61, v7
v_cvt_pk_bf16_f32 v9, v7, v7
v_lshlrev_b32 v7, 16, v9
v_add_f32 v6, v6, v7
v_cvt_pk_bf16_f32 v9, v6, v6
v_lshlrev_b32 v6, 16, v9
v_lshlrev_b32 v7, 16, v29
v_mul_f32 v7, s60, v7
v_cvt_pk_bf16_f32 v9, v7, v7
v_lshlrev_b32 v7, 16, v9
v_add_f32 v6, v6, v7
v_cvt_pk_bf16_f32 v9, v6, v6
v_lshlrev_b32 v6, 16, v9
v_lshlrev_b32 v7, 16, v45
v_mul_f32 v6, v6, v7
v_cvt_pk_bf16_f32 v9, v6, v6
v_lshlrev_b32 v6, 16, v9
v_mul_f32 v90, s70, v6
v_cvt_pk_bf16_f32 v9, v90, v90
v_lshlrev_b32 v90, 16, v9
v_lshrrev_b32 v107, 16, v6
v_and_b32 v7, 0xffff0000, v23
v_mul_f32 v7, s67, v7
v_cvt_pk_bf16_f32 v9, v7, v7
v_lshlrev_b32 v7, 16, v9
v_mov_b32 v6, v7
v_and_b32 v7, 0xffff0000, v25
v_mul_f32 v7, s66, v7
v_cvt_pk_bf16_f32 v9, v7, v7
v_lshlrev_b32 v7, 16, v9
v_add_f32 v6, v6, v7
v_cvt_pk_bf16_f32 v9, v6, v6
v_lshlrev_b32 v6, 16, v9
v_and_b32 v7, 0xffff0000, v27
v_mul_f32 v7, s65, v7
v_cvt_pk_bf16_f32 v9, v7, v7
v_lshlrev_b32 v7, 16, v9
v_add_f32 v6, v6, v7
v_cvt_pk_bf16_f32 v9, v6, v6
v_lshlrev_b32 v6, 16, v9
v_and_b32 v7, 0xffff0000, v29
v_mul_f32 v7, s64, v7
v_cvt_pk_bf16_f32 v9, v7, v7
v_lshlrev_b32 v7, 16, v9
v_add_f32 v6, v6, v7
v_cvt_pk_bf16_f32 v9, v6, v6
v_lshlrev_b32 v6, 16, v9
v_and_b32 v7, 0xffff0000, v45
v_mul_f32 v6, v6, v7
v_cvt_pk_bf16_f32 v9, v6, v6
v_lshlrev_b32 v6, 16, v9
v_mul_f32 v91, s71, v6
v_cvt_pk_bf16_f32 v9, v91, v91
v_lshlrev_b32 v91, 16, v9
v_lshrrev_b32 v111, 16, v6
v_lshlrev_b32 v7, 16, v24
v_mul_f32 v7, s55, v7
v_cvt_pk_bf16_f32 v9, v7, v7
v_lshlrev_b32 v7, 16, v9
v_mov_b32 v6, v7
v_lshlrev_b32 v7, 16, v26
v_mul_f32 v7, s54, v7
v_cvt_pk_bf16_f32 v9, v7, v7
v_lshlrev_b32 v7, 16, v9
v_add_f32 v6, v6, v7
v_cvt_pk_bf16_f32 v9, v6, v6
v_lshlrev_b32 v6, 16, v9
v_lshlrev_b32 v7, 16, v28
v_mul_f32 v7, s53, v7
v_cvt_pk_bf16_f32 v9, v7, v7
v_lshlrev_b32 v7, 16, v9
v_add_f32 v6, v6, v7
v_cvt_pk_bf16_f32 v9, v6, v6
v_lshlrev_b32 v6, 16, v9
v_lshlrev_b32 v7, 16, v30
v_mul_f32 v7, s52, v7
v_cvt_pk_bf16_f32 v9, v7, v7
v_lshlrev_b32 v7, 16, v9
v_add_f32 v6, v6, v7
v_cvt_pk_bf16_f32 v9, v6, v6
v_lshlrev_b32 v6, 16, v9
v_lshlrev_b32 v7, 16, v46
v_mul_f32 v6, v6, v7
v_cvt_pk_bf16_f32 v9, v6, v6
v_lshlrev_b32 v6, 16, v9
v_mul_f32 v92, s68, v6
v_cvt_pk_bf16_f32 v9, v92, v92
v_lshlrev_b32 v92, 16, v9
v_or_b32 v99, v99, v6
v_and_b32 v7, 0xffff0000, v24
v_mul_f32 v7, s59, v7
v_cvt_pk_bf16_f32 v9, v7, v7
v_lshlrev_b32 v7, 16, v9
v_mov_b32 v6, v7
v_and_b32 v7, 0xffff0000, v26
v_mul_f32 v7, s58, v7
v_cvt_pk_bf16_f32 v9, v7, v7
v_lshlrev_b32 v7, 16, v9
v_add_f32 v6, v6, v7
v_cvt_pk_bf16_f32 v9, v6, v6
v_lshlrev_b32 v6, 16, v9
v_and_b32 v7, 0xffff0000, v28
v_mul_f32 v7, s57, v7
v_cvt_pk_bf16_f32 v9, v7, v7
v_lshlrev_b32 v7, 16, v9
v_add_f32 v6, v6, v7
v_cvt_pk_bf16_f32 v9, v6, v6
v_lshlrev_b32 v6, 16, v9
v_and_b32 v7, 0xffff0000, v30
v_mul_f32 v7, s56, v7
v_cvt_pk_bf16_f32 v9, v7, v7
v_lshlrev_b32 v7, 16, v9
v_add_f32 v6, v6, v7
v_cvt_pk_bf16_f32 v9, v6, v6
v_lshlrev_b32 v6, 16, v9
v_and_b32 v7, 0xffff0000, v46
v_mul_f32 v6, v6, v7
v_cvt_pk_bf16_f32 v9, v6, v6
v_lshlrev_b32 v6, 16, v9
v_mul_f32 v93, s69, v6
v_cvt_pk_bf16_f32 v9, v93, v93
v_lshlrev_b32 v93, 16, v9
v_or_b32 v103, v103, v6
v_lshlrev_b32 v7, 16, v25
v_mul_f32 v7, s63, v7
v_cvt_pk_bf16_f32 v9, v7, v7
v_lshlrev_b32 v7, 16, v9
v_mov_b32 v6, v7
v_lshlrev_b32 v7, 16, v27
v_mul_f32 v7, s62, v7
v_cvt_pk_bf16_f32 v9, v7, v7
v_lshlrev_b32 v7, 16, v9
v_add_f32 v6, v6, v7
v_cvt_pk_bf16_f32 v9, v6, v6
v_lshlrev_b32 v6, 16, v9
v_lshlrev_b32 v7, 16, v29
v_mul_f32 v7, s61, v7
v_cvt_pk_bf16_f32 v9, v7, v7
v_lshlrev_b32 v7, 16, v9
v_add_f32 v6, v6, v7
v_cvt_pk_bf16_f32 v9, v6, v6
v_lshlrev_b32 v6, 16, v9
v_lshlrev_b32 v7, 16, v31
v_mul_f32 v7, s60, v7
v_cvt_pk_bf16_f32 v9, v7, v7
v_lshlrev_b32 v7, 16, v9
v_add_f32 v6, v6, v7
v_cvt_pk_bf16_f32 v9, v6, v6
v_lshlrev_b32 v6, 16, v9
v_lshlrev_b32 v7, 16, v47
v_mul_f32 v6, v6, v7
v_cvt_pk_bf16_f32 v9, v6, v6
v_lshlrev_b32 v6, 16, v9
v_mul_f32 v94, s70, v6
v_cvt_pk_bf16_f32 v9, v94, v94
v_lshlrev_b32 v94, 16, v9
v_or_b32 v107, v107, v6
v_and_b32 v7, 0xffff0000, v25
v_mul_f32 v7, s67, v7
v_cvt_pk_bf16_f32 v9, v7, v7
v_lshlrev_b32 v7, 16, v9
v_mov_b32 v6, v7
v_and_b32 v7, 0xffff0000, v27
v_mul_f32 v7, s66, v7
v_cvt_pk_bf16_f32 v9, v7, v7
v_lshlrev_b32 v7, 16, v9
v_add_f32 v6, v6, v7
v_cvt_pk_bf16_f32 v9, v6, v6
v_lshlrev_b32 v6, 16, v9
v_and_b32 v7, 0xffff0000, v29
v_mul_f32 v7, s65, v7
v_cvt_pk_bf16_f32 v9, v7, v7
v_lshlrev_b32 v7, 16, v9
v_add_f32 v6, v6, v7
v_cvt_pk_bf16_f32 v9, v6, v6
v_lshlrev_b32 v6, 16, v9
v_and_b32 v7, 0xffff0000, v31
v_mul_f32 v7, s64, v7
v_cvt_pk_bf16_f32 v9, v7, v7
v_lshlrev_b32 v7, 16, v9
v_add_f32 v6, v6, v7
v_cvt_pk_bf16_f32 v9, v6, v6
v_lshlrev_b32 v6, 16, v9
v_and_b32 v7, 0xffff0000, v47
v_mul_f32 v6, v6, v7
v_cvt_pk_bf16_f32 v9, v6, v6
v_lshlrev_b32 v6, 16, v9
v_mul_f32 v95, s71, v6
v_cvt_pk_bf16_f32 v9, v95, v95
v_lshlrev_b32 v95, 16, v9
v_or_b32 v111, v111, v6
v_lshlrev_b32 v6, 4, v0
v_mov_b32 v112, 0
v_mov_b32 v113, 0
v_mov_b32 v114, 0
v_mov_b32 v115, 0
v_add_u32 v7, 33536, v6
ds_write_b128 v7, v[96:99] offset:2048
v_add_u32 v7, 73216, v6
ds_write_b128 v7, v[100:103] offset:2048
v_add_u32 v7, 112896, v6
ds_write_b128 v7, v[104:107] offset:2048
v_add_u32 v7, 152576, v6
ds_write_b128 v7, v[108:111] offset:2048
v_cmp_gt_u32 vcc, 128, v0
s_and_saveexec_b64 s[72:73], vcc
v_add_u32 v7, 33536, v6
ds_write_b128 v7, v[112:115]
v_add_u32 v7, 73216, v6
ds_write_b128 v7, v[112:115]
v_add_u32 v7, 112896, v6
ds_write_b128 v7, v[112:115]
v_add_u32 v7, 152576, v6
ds_write_b128 v7, v[112:115]
s_mov_b64 exec, s[72:73]
s_mul_i32 s18, s19, 39680
v_lshlrev_b32 v5, 1, v2
v_add_u32 v7, s18, v5
ds_write_b16 v7, v112 offset:4096
ds_write_b16 v7, v112 offset:8288
ds_write_b16 v7, v112 offset:12480
ds_write_b16 v7, v112 offset:16672
ds_write_b16 v7, v112 offset:20864
ds_write_b16 v7, v112 offset:25056
ds_write_b16 v7, v112 offset:29248
ds_write_b16 v7, v112 offset:33440
v_sub_u32 v7, s18, v5
v_add_u32 v7, 126, v7
s_waitcnt vmcnt(0)
ds_write_b16 v7, v128 offset:3984
ds_write_b16 v7, v128 offset:8174
ds_write_b16 v7, v128 offset:12364
ds_write_b16 v7, v128 offset:16554
ds_write_b16 v7, v128 offset:20744
ds_write_b16 v7, v128 offset:24934
ds_write_b16 v7, v128 offset:29124
ds_write_b16 v7, v128 offset:33314
ds_write_b16 v7, v129 offset:3856
ds_write_b16 v7, v129 offset:8046
ds_write_b16 v7, v129 offset:12236
ds_write_b16 v7, v129 offset:16426
ds_write_b16 v7, v129 offset:20616
ds_write_b16 v7, v129 offset:24806
ds_write_b16 v7, v129 offset:28996
ds_write_b16 v7, v129 offset:33186
ds_write_b16 v7, v130 offset:3728
ds_write_b16 v7, v130 offset:7918
ds_write_b16 v7, v130 offset:12108
ds_write_b16 v7, v130 offset:16298
ds_write_b16 v7, v130 offset:20488
ds_write_b16 v7, v130 offset:24678
ds_write_b16 v7, v130 offset:28868
ds_write_b16 v7, v130 offset:33058
ds_write_b16 v7, v131 offset:3600
ds_write_b16 v7, v131 offset:7790
ds_write_b16 v7, v131 offset:11980
ds_write_b16 v7, v131 offset:16170
ds_write_b16 v7, v131 offset:20360
ds_write_b16 v7, v131 offset:24550
ds_write_b16 v7, v131 offset:28740
ds_write_b16 v7, v131 offset:32930
ds_write_b16 v7, v132 offset:3472
ds_write_b16 v7, v132 offset:7662
ds_write_b16 v7, v132 offset:11852
ds_write_b16 v7, v132 offset:16042
ds_write_b16 v7, v132 offset:20232
ds_write_b16 v7, v132 offset:24422
ds_write_b16 v7, v132 offset:28612
ds_write_b16 v7, v132 offset:32802
ds_write_b16 v7, v133 offset:3344
ds_write_b16 v7, v133 offset:7534
ds_write_b16 v7, v133 offset:11724
ds_write_b16 v7, v133 offset:15914
ds_write_b16 v7, v133 offset:20104
ds_write_b16 v7, v133 offset:24294
ds_write_b16 v7, v133 offset:28484
ds_write_b16 v7, v133 offset:32674
ds_write_b16 v7, v134 offset:3216
ds_write_b16 v7, v134 offset:7406
ds_write_b16 v7, v134 offset:11596
ds_write_b16 v7, v134 offset:15786
ds_write_b16 v7, v134 offset:19976
ds_write_b16 v7, v134 offset:24166
ds_write_b16 v7, v134 offset:28356
ds_write_b16 v7, v134 offset:32546
ds_write_b16 v7, v135 offset:3088
ds_write_b16 v7, v135 offset:7278
ds_write_b16 v7, v135 offset:11468
ds_write_b16 v7, v135 offset:15658
ds_write_b16 v7, v135 offset:19848
ds_write_b16 v7, v135 offset:24038
ds_write_b16 v7, v135 offset:28228
ds_write_b16 v7, v135 offset:32418
ds_write_b16 v7, v136 offset:2960
ds_write_b16 v7, v136 offset:7150
ds_write_b16 v7, v136 offset:11340
ds_write_b16 v7, v136 offset:15530
ds_write_b16 v7, v136 offset:19720
ds_write_b16 v7, v136 offset:23910
ds_write_b16 v7, v136 offset:28100
ds_write_b16 v7, v136 offset:32290
ds_write_b16 v7, v137 offset:2832
ds_write_b16 v7, v137 offset:7022
ds_write_b16 v7, v137 offset:11212
ds_write_b16 v7, v137 offset:15402
ds_write_b16 v7, v137 offset:19592
ds_write_b16 v7, v137 offset:23782
ds_write_b16 v7, v137 offset:27972
ds_write_b16 v7, v137 offset:32162
ds_write_b16 v7, v138 offset:2704
ds_write_b16 v7, v138 offset:6894
ds_write_b16 v7, v138 offset:11084
ds_write_b16 v7, v138 offset:15274
ds_write_b16 v7, v138 offset:19464
ds_write_b16 v7, v138 offset:23654
ds_write_b16 v7, v138 offset:27844
ds_write_b16 v7, v138 offset:32034
ds_write_b16 v7, v139 offset:2576
ds_write_b16 v7, v139 offset:6766
ds_write_b16 v7, v139 offset:10956
ds_write_b16 v7, v139 offset:15146
ds_write_b16 v7, v139 offset:19336
ds_write_b16 v7, v139 offset:23526
ds_write_b16 v7, v139 offset:27716
ds_write_b16 v7, v139 offset:31906
ds_write_b16 v7, v140 offset:2448
ds_write_b16 v7, v140 offset:6638
ds_write_b16 v7, v140 offset:10828
ds_write_b16 v7, v140 offset:15018
ds_write_b16 v7, v140 offset:19208
ds_write_b16 v7, v140 offset:23398
ds_write_b16 v7, v140 offset:27588
ds_write_b16 v7, v140 offset:31778
ds_write_b16 v7, v141 offset:2320
ds_write_b16 v7, v141 offset:6510
ds_write_b16 v7, v141 offset:10700
ds_write_b16 v7, v141 offset:14890
ds_write_b16 v7, v141 offset:19080
ds_write_b16 v7, v141 offset:23270
ds_write_b16 v7, v141 offset:27460
ds_write_b16 v7, v141 offset:31650
ds_write_b16 v7, v142 offset:2192
ds_write_b16 v7, v142 offset:6382
ds_write_b16 v7, v142 offset:10572
ds_write_b16 v7, v142 offset:14762
ds_write_b16 v7, v142 offset:18952
ds_write_b16 v7, v142 offset:23142
ds_write_b16 v7, v142 offset:27332
ds_write_b16 v7, v142 offset:31522
ds_write_b16 v7, v143 offset:2064
ds_write_b16 v7, v143 offset:6254
ds_write_b16 v7, v143 offset:10444
ds_write_b16 v7, v143 offset:14634
ds_write_b16 v7, v143 offset:18824
ds_write_b16 v7, v143 offset:23014
ds_write_b16 v7, v143 offset:27204
ds_write_b16 v7, v143 offset:31394
ds_write_b16 v7, v144 offset:1936
ds_write_b16 v7, v144 offset:6126
ds_write_b16 v7, v144 offset:10316
ds_write_b16 v7, v144 offset:14506
ds_write_b16 v7, v144 offset:18696
ds_write_b16 v7, v144 offset:22886
ds_write_b16 v7, v144 offset:27076
ds_write_b16 v7, v144 offset:31266
ds_write_b16 v7, v145 offset:1808
ds_write_b16 v7, v145 offset:5998
ds_write_b16 v7, v145 offset:10188
ds_write_b16 v7, v145 offset:14378
ds_write_b16 v7, v145 offset:18568
ds_write_b16 v7, v145 offset:22758
ds_write_b16 v7, v145 offset:26948
ds_write_b16 v7, v145 offset:31138
ds_write_b16 v7, v146 offset:1680
ds_write_b16 v7, v146 offset:5870
ds_write_b16 v7, v146 offset:10060
ds_write_b16 v7, v146 offset:14250
ds_write_b16 v7, v146 offset:18440
ds_write_b16 v7, v146 offset:22630
ds_write_b16 v7, v146 offset:26820
ds_write_b16 v7, v146 offset:31010
ds_write_b16 v7, v147 offset:1552
ds_write_b16 v7, v147 offset:5742
ds_write_b16 v7, v147 offset:9932
ds_write_b16 v7, v147 offset:14122
ds_write_b16 v7, v147 offset:18312
ds_write_b16 v7, v147 offset:22502
ds_write_b16 v7, v147 offset:26692
ds_write_b16 v7, v147 offset:30882
ds_write_b16 v7, v148 offset:1424
ds_write_b16 v7, v148 offset:5614
ds_write_b16 v7, v148 offset:9804
ds_write_b16 v7, v148 offset:13994
ds_write_b16 v7, v148 offset:18184
ds_write_b16 v7, v148 offset:22374
ds_write_b16 v7, v148 offset:26564
ds_write_b16 v7, v148 offset:30754
ds_write_b16 v7, v149 offset:1296
ds_write_b16 v7, v149 offset:5486
ds_write_b16 v7, v149 offset:9676
ds_write_b16 v7, v149 offset:13866
ds_write_b16 v7, v149 offset:18056
ds_write_b16 v7, v149 offset:22246
ds_write_b16 v7, v149 offset:26436
ds_write_b16 v7, v149 offset:30626
ds_write_b16 v7, v150 offset:1168
ds_write_b16 v7, v150 offset:5358
ds_write_b16 v7, v150 offset:9548
ds_write_b16 v7, v150 offset:13738
ds_write_b16 v7, v150 offset:17928
ds_write_b16 v7, v150 offset:22118
ds_write_b16 v7, v150 offset:26308
ds_write_b16 v7, v150 offset:30498
ds_write_b16 v7, v151 offset:1040
ds_write_b16 v7, v151 offset:5230
ds_write_b16 v7, v151 offset:9420
ds_write_b16 v7, v151 offset:13610
ds_write_b16 v7, v151 offset:17800
ds_write_b16 v7, v151 offset:21990
ds_write_b16 v7, v151 offset:26180
ds_write_b16 v7, v151 offset:30370
ds_write_b16 v7, v152 offset:912
ds_write_b16 v7, v152 offset:5102
ds_write_b16 v7, v152 offset:9292
ds_write_b16 v7, v152 offset:13482
ds_write_b16 v7, v152 offset:17672
ds_write_b16 v7, v152 offset:21862
ds_write_b16 v7, v152 offset:26052
ds_write_b16 v7, v152 offset:30242
ds_write_b16 v7, v153 offset:784
ds_write_b16 v7, v153 offset:4974
ds_write_b16 v7, v153 offset:9164
ds_write_b16 v7, v153 offset:13354
ds_write_b16 v7, v153 offset:17544
ds_write_b16 v7, v153 offset:21734
ds_write_b16 v7, v153 offset:25924
ds_write_b16 v7, v153 offset:30114
ds_write_b16 v7, v154 offset:656
ds_write_b16 v7, v154 offset:4846
ds_write_b16 v7, v154 offset:9036
ds_write_b16 v7, v154 offset:13226
ds_write_b16 v7, v154 offset:17416
ds_write_b16 v7, v154 offset:21606
ds_write_b16 v7, v154 offset:25796
ds_write_b16 v7, v154 offset:29986
ds_write_b16 v7, v155 offset:528
ds_write_b16 v7, v155 offset:4718
ds_write_b16 v7, v155 offset:8908
ds_write_b16 v7, v155 offset:13098
ds_write_b16 v7, v155 offset:17288
ds_write_b16 v7, v155 offset:21478
ds_write_b16 v7, v155 offset:25668
ds_write_b16 v7, v155 offset:29858
ds_write_b16 v7, v156 offset:400
ds_write_b16 v7, v156 offset:4590
ds_write_b16 v7, v156 offset:8780
ds_write_b16 v7, v156 offset:12970
ds_write_b16 v7, v156 offset:17160
ds_write_b16 v7, v156 offset:21350
ds_write_b16 v7, v156 offset:25540
ds_write_b16 v7, v156 offset:29730
ds_write_b16 v7, v157 offset:272
ds_write_b16 v7, v157 offset:4462
ds_write_b16 v7, v157 offset:8652
ds_write_b16 v7, v157 offset:12842
ds_write_b16 v7, v157 offset:17032
ds_write_b16 v7, v157 offset:21222
ds_write_b16 v7, v157 offset:25412
ds_write_b16 v7, v157 offset:29602
ds_write_b16 v7, v158 offset:144
ds_write_b16 v7, v158 offset:4334
ds_write_b16 v7, v158 offset:8524
ds_write_b16 v7, v158 offset:12714
ds_write_b16 v7, v158 offset:16904
ds_write_b16 v7, v158 offset:21094
ds_write_b16 v7, v158 offset:25284
ds_write_b16 v7, v158 offset:29474
ds_write_b16 v7, v159 offset:16
ds_write_b16 v7, v159 offset:4206
ds_write_b16 v7, v159 offset:8396
ds_write_b16 v7, v159 offset:12586
ds_write_b16 v7, v159 offset:16776
ds_write_b16 v7, v159 offset:20966
ds_write_b16 v7, v159 offset:25156
ds_write_b16 v7, v159 offset:29346
s_waitcnt lgkmcnt(0)
s_barrier
v_and_b32 v5, 31, v2
v_lshrrev_b32 v6, 5, v2
v_sub_u32 v7, 7, v5
v_and_b32 v7, 7, v7
v_lshlrev_b32 v8, 3, v6
v_sub_u32 v8, v8, v5
v_add_u32 v8, 31, v8
v_sub_u32 v8, v8, v7
v_lshlrev_b32 v8, 1, v8
v_mul_u32_u24 v7, 4192, v7
v_add3_u32 v116, v7, v8, s18
v_add_u32 v116, 16, v116
v_lshlrev_b32 v7, 6, v5
v_lshlrev_b32 v8, 4, v6
v_add3_u32 v117, v7, v8, s18
v_add_u32 v117, 33536, v117
v_mov_b32 v160, 0
v_mov_b32 v161, 0
v_mov_b32 v162, 0
v_mov_b32 v163, 0
v_mov_b32 v164, 0
v_mov_b32 v165, 0
v_mov_b32 v166, 0
v_mov_b32 v167, 0
v_mov_b32 v168, 0
v_mov_b32 v169, 0
v_mov_b32 v170, 0
v_mov_b32 v171, 0
v_mov_b32 v172, 0
v_mov_b32 v173, 0
v_mov_b32 v174, 0
v_mov_b32 v175, 0
v_mov_b32 v176, 0
v_mov_b32 v177, 0
v_mov_b32 v178, 0
v_mov_b32 v179, 0
v_mov_b32 v180, 0
v_mov_b32 v181, 0
v_mov_b32 v182, 0
v_mov_b32 v183, 0
v_mov_b32 v184, 0
v_mov_b32 v185, 0
v_mov_b32 v186, 0
v_mov_b32 v187, 0
v_mov_b32 v188, 0
v_mov_b32 v189, 0
v_mov_b32 v190, 0
v_mov_b32 v191, 0
ds_read_b128 v[192:195], v116 offset:4032
ds_read_b128 v[200:203], v117 offset:4096
ds_read_b128 v[208:211], v117 offset:2048
ds_read_b128 v[196:199], v116 offset:4064
ds_read_b128 v[204:207], v117 offset:4128
ds_read_b128 v[212:215], v117 offset:2080
ds_read_b128 v[216:219], v116 offset:3968
ds_read_b128 v[224:227], v117 offset:4032
ds_read_b128 v[232:235], v117 offset:1984
ds_read_b128 v[220:223], v116 offset:4000
ds_read_b128 v[228:231], v117 offset:4064
ds_read_b128 v[236:239], v117 offset:2016
s_waitcnt lgkmcnt(6)
v_mfma_f32_32x32x16_bf16 v[176:191], v[192:195], v[200:203], v[176:191]
v_mfma_f32_32x32x16_bf16 v[160:175], v[192:195], v[208:211], v[160:175]
v_mfma_f32_32x32x16_bf16 v[176:191], v[196:199], v[204:207], v[176:191]
v_mfma_f32_32x32x16_bf16 v[160:175], v[196:199], v[212:215], v[160:175]
ds_read_b128 v[192:195], v116 offset:3904
ds_read_b128 v[200:203], v117 offset:3968
ds_read_b128 v[208:211], v117 offset:1920
ds_read_b128 v[196:199], v116 offset:3936
ds_read_b128 v[204:207], v117 offset:4000
ds_read_b128 v[212:215], v117 offset:1952
s_waitcnt lgkmcnt(6)
v_mfma_f32_32x32x16_bf16 v[176:191], v[216:219], v[224:227], v[176:191]
v_mfma_f32_32x32x16_bf16 v[160:175], v[216:219], v[232:235], v[160:175]
v_mfma_f32_32x32x16_bf16 v[176:191], v[220:223], v[228:231], v[176:191]
v_mfma_f32_32x32x16_bf16 v[160:175], v[220:223], v[236:239], v[160:175]
ds_read_b128 v[216:219], v116 offset:3840
ds_read_b128 v[224:227], v117 offset:3904
ds_read_b128 v[232:235], v117 offset:1856
ds_read_b128 v[220:223], v116 offset:3872
ds_read_b128 v[228:231], v117 offset:3936
ds_read_b128 v[236:239], v117 offset:1888
s_waitcnt lgkmcnt(6)
v_mfma_f32_32x32x16_bf16 v[176:191], v[192:195], v[200:203], v[176:191]
v_mfma_f32_32x32x16_bf16 v[160:175], v[192:195], v[208:211], v[160:175]
v_mfma_f32_32x32x16_bf16 v[176:191], v[196:199], v[204:207], v[176:191]
v_mfma_f32_32x32x16_bf16 v[160:175], v[196:199], v[212:215], v[160:175]
ds_read_b128 v[192:195], v116 offset:3776
ds_read_b128 v[200:203], v117 offset:3840
ds_read_b128 v[208:211], v117 offset:1792
ds_read_b128 v[196:199], v116 offset:3808
ds_read_b128 v[204:207], v117 offset:3872
ds_read_b128 v[212:215], v117 offset:1824
s_waitcnt lgkmcnt(6)
v_mfma_f32_32x32x16_bf16 v[176:191], v[216:219], v[224:227], v[176:191]
v_mfma_f32_32x32x16_bf16 v[160:175], v[216:219], v[232:235], v[160:175]
v_mfma_f32_32x32x16_bf16 v[176:191], v[220:223], v[228:231], v[176:191]
v_mfma_f32_32x32x16_bf16 v[160:175], v[220:223], v[236:239], v[160:175]
ds_read_b128 v[216:219], v116 offset:3712
ds_read_b128 v[224:227], v117 offset:3776
ds_read_b128 v[232:235], v117 offset:1728
ds_read_b128 v[220:223], v116 offset:3744
ds_read_b128 v[228:231], v117 offset:3808
ds_read_b128 v[236:239], v117 offset:1760
s_waitcnt lgkmcnt(6)
v_mfma_f32_32x32x16_bf16 v[176:191], v[192:195], v[200:203], v[176:191]
v_mfma_f32_32x32x16_bf16 v[160:175], v[192:195], v[208:211], v[160:175]
v_mfma_f32_32x32x16_bf16 v[176:191], v[196:199], v[204:207], v[176:191]
v_mfma_f32_32x32x16_bf16 v[160:175], v[196:199], v[212:215], v[160:175]
ds_read_b128 v[192:195], v116 offset:3648
ds_read_b128 v[200:203], v117 offset:3712
ds_read_b128 v[208:211], v117 offset:1664
ds_read_b128 v[196:199], v116 offset:3680
ds_read_b128 v[204:207], v117 offset:3744
ds_read_b128 v[212:215], v117 offset:1696
s_waitcnt lgkmcnt(6)
v_mfma_f32_32x32x16_bf16 v[176:191], v[216:219], v[224:227], v[176:191]
v_mfma_f32_32x32x16_bf16 v[160:175], v[216:219], v[232:235], v[160:175]
v_mfma_f32_32x32x16_bf16 v[176:191], v[220:223], v[228:231], v[176:191]
v_mfma_f32_32x32x16_bf16 v[160:175], v[220:223], v[236:239], v[160:175]
ds_read_b128 v[216:219], v116 offset:3584
ds_read_b128 v[224:227], v117 offset:3648
ds_read_b128 v[232:235], v117 offset:1600
ds_read_b128 v[220:223], v116 offset:3616
ds_read_b128 v[228:231], v117 offset:3680
ds_read_b128 v[236:239], v117 offset:1632
s_waitcnt lgkmcnt(6)
v_mfma_f32_32x32x16_bf16 v[176:191], v[192:195], v[200:203], v[176:191]
v_mfma_f32_32x32x16_bf16 v[160:175], v[192:195], v[208:211], v[160:175]
v_mfma_f32_32x32x16_bf16 v[176:191], v[196:199], v[204:207], v[176:191]
v_mfma_f32_32x32x16_bf16 v[160:175], v[196:199], v[212:215], v[160:175]
ds_read_b128 v[192:195], v116 offset:3520
ds_read_b128 v[200:203], v117 offset:3584
ds_read_b128 v[208:211], v117 offset:1536
ds_read_b128 v[196:199], v116 offset:3552
ds_read_b128 v[204:207], v117 offset:3616
ds_read_b128 v[212:215], v117 offset:1568
s_waitcnt lgkmcnt(6)
v_mfma_f32_32x32x16_bf16 v[176:191], v[216:219], v[224:227], v[176:191]
v_mfma_f32_32x32x16_bf16 v[160:175], v[216:219], v[232:235], v[160:175]
v_mfma_f32_32x32x16_bf16 v[176:191], v[220:223], v[228:231], v[176:191]
v_mfma_f32_32x32x16_bf16 v[160:175], v[220:223], v[236:239], v[160:175]
ds_read_b128 v[216:219], v116 offset:3456
ds_read_b128 v[224:227], v117 offset:3520
ds_read_b128 v[232:235], v117 offset:1472
ds_read_b128 v[220:223], v116 offset:3488
ds_read_b128 v[228:231], v117 offset:3552
ds_read_b128 v[236:239], v117 offset:1504
s_waitcnt lgkmcnt(6)
v_mfma_f32_32x32x16_bf16 v[176:191], v[192:195], v[200:203], v[176:191]
v_mfma_f32_32x32x16_bf16 v[160:175], v[192:195], v[208:211], v[160:175]
v_mfma_f32_32x32x16_bf16 v[176:191], v[196:199], v[204:207], v[176:191]
v_mfma_f32_32x32x16_bf16 v[160:175], v[196:199], v[212:215], v[160:175]
ds_read_b128 v[192:195], v116 offset:3392
ds_read_b128 v[200:203], v117 offset:3456
ds_read_b128 v[208:211], v117 offset:1408
ds_read_b128 v[196:199], v116 offset:3424
ds_read_b128 v[204:207], v117 offset:3488
ds_read_b128 v[212:215], v117 offset:1440
s_waitcnt lgkmcnt(6)
v_mfma_f32_32x32x16_bf16 v[176:191], v[216:219], v[224:227], v[176:191]
v_mfma_f32_32x32x16_bf16 v[160:175], v[216:219], v[232:235], v[160:175]
v_mfma_f32_32x32x16_bf16 v[176:191], v[220:223], v[228:231], v[176:191]
v_mfma_f32_32x32x16_bf16 v[160:175], v[220:223], v[236:239], v[160:175]
ds_read_b128 v[216:219], v116 offset:3328
ds_read_b128 v[224:227], v117 offset:3392
ds_read_b128 v[232:235], v117 offset:1344
ds_read_b128 v[220:223], v116 offset:3360
ds_read_b128 v[228:231], v117 offset:3424
ds_read_b128 v[236:239], v117 offset:1376
s_waitcnt lgkmcnt(6)
v_mfma_f32_32x32x16_bf16 v[176:191], v[192:195], v[200:203], v[176:191]
v_mfma_f32_32x32x16_bf16 v[160:175], v[192:195], v[208:211], v[160:175]
v_mfma_f32_32x32x16_bf16 v[176:191], v[196:199], v[204:207], v[176:191]
v_mfma_f32_32x32x16_bf16 v[160:175], v[196:199], v[212:215], v[160:175]
ds_read_b128 v[192:195], v116 offset:3264
ds_read_b128 v[200:203], v117 offset:3328
ds_read_b128 v[208:211], v117 offset:1280
ds_read_b128 v[196:199], v116 offset:3296
ds_read_b128 v[204:207], v117 offset:3360
ds_read_b128 v[212:215], v117 offset:1312
s_waitcnt lgkmcnt(6)
v_mfma_f32_32x32x16_bf16 v[176:191], v[216:219], v[224:227], v[176:191]
v_mfma_f32_32x32x16_bf16 v[160:175], v[216:219], v[232:235], v[160:175]
v_mfma_f32_32x32x16_bf16 v[176:191], v[220:223], v[228:231], v[176:191]
v_mfma_f32_32x32x16_bf16 v[160:175], v[220:223], v[236:239], v[160:175]
ds_read_b128 v[216:219], v116 offset:3200
ds_read_b128 v[224:227], v117 offset:3264
ds_read_b128 v[232:235], v117 offset:1216
ds_read_b128 v[220:223], v116 offset:3232
ds_read_b128 v[228:231], v117 offset:3296
ds_read_b128 v[236:239], v117 offset:1248
s_waitcnt lgkmcnt(6)
v_mfma_f32_32x32x16_bf16 v[176:191], v[192:195], v[200:203], v[176:191]
v_mfma_f32_32x32x16_bf16 v[160:175], v[192:195], v[208:211], v[160:175]
v_mfma_f32_32x32x16_bf16 v[176:191], v[196:199], v[204:207], v[176:191]
v_mfma_f32_32x32x16_bf16 v[160:175], v[196:199], v[212:215], v[160:175]
ds_read_b128 v[192:195], v116 offset:3136
ds_read_b128 v[200:203], v117 offset:3200
ds_read_b128 v[208:211], v117 offset:1152
ds_read_b128 v[196:199], v116 offset:3168
ds_read_b128 v[204:207], v117 offset:3232
ds_read_b128 v[212:215], v117 offset:1184
s_waitcnt lgkmcnt(6)
v_mfma_f32_32x32x16_bf16 v[176:191], v[216:219], v[224:227], v[176:191]
v_mfma_f32_32x32x16_bf16 v[160:175], v[216:219], v[232:235], v[160:175]
v_mfma_f32_32x32x16_bf16 v[176:191], v[220:223], v[228:231], v[176:191]
v_mfma_f32_32x32x16_bf16 v[160:175], v[220:223], v[236:239], v[160:175]
ds_read_b128 v[216:219], v116 offset:3072
ds_read_b128 v[224:227], v117 offset:3136
ds_read_b128 v[232:235], v117 offset:1088
ds_read_b128 v[220:223], v116 offset:3104
ds_read_b128 v[228:231], v117 offset:3168
ds_read_b128 v[236:239], v117 offset:1120
s_waitcnt lgkmcnt(6)
v_mfma_f32_32x32x16_bf16 v[176:191], v[192:195], v[200:203], v[176:191]
v_mfma_f32_32x32x16_bf16 v[160:175], v[192:195], v[208:211], v[160:175]
v_mfma_f32_32x32x16_bf16 v[176:191], v[196:199], v[204:207], v[176:191]
v_mfma_f32_32x32x16_bf16 v[160:175], v[196:199], v[212:215], v[160:175]
ds_read_b128 v[192:195], v116 offset:3008
ds_read_b128 v[200:203], v117 offset:3072
ds_read_b128 v[208:211], v117 offset:1024
ds_read_b128 v[196:199], v116 offset:3040
ds_read_b128 v[204:207], v117 offset:3104
ds_read_b128 v[212:215], v117 offset:1056
s_waitcnt lgkmcnt(6)
v_mfma_f32_32x32x16_bf16 v[176:191], v[216:219], v[224:227], v[176:191]
v_mfma_f32_32x32x16_bf16 v[160:175], v[216:219], v[232:235], v[160:175]
v_mfma_f32_32x32x16_bf16 v[176:191], v[220:223], v[228:231], v[176:191]
v_mfma_f32_32x32x16_bf16 v[160:175], v[220:223], v[236:239], v[160:175]
ds_read_b128 v[216:219], v116 offset:2944
ds_read_b128 v[224:227], v117 offset:3008
ds_read_b128 v[232:235], v117 offset:960
ds_read_b128 v[220:223], v116 offset:2976
ds_read_b128 v[228:231], v117 offset:3040
ds_read_b128 v[236:239], v117 offset:992
s_waitcnt lgkmcnt(6)
v_mfma_f32_32x32x16_bf16 v[176:191], v[192:195], v[200:203], v[176:191]
v_mfma_f32_32x32x16_bf16 v[160:175], v[192:195], v[208:211], v[160:175]
v_mfma_f32_32x32x16_bf16 v[176:191], v[196:199], v[204:207], v[176:191]
v_mfma_f32_32x32x16_bf16 v[160:175], v[196:199], v[212:215], v[160:175]
ds_read_b128 v[192:195], v116 offset:2880
ds_read_b128 v[200:203], v117 offset:2944
ds_read_b128 v[208:211], v117 offset:896
ds_read_b128 v[196:199], v116 offset:2912
ds_read_b128 v[204:207], v117 offset:2976
ds_read_b128 v[212:215], v117 offset:928
s_waitcnt lgkmcnt(6)
v_mfma_f32_32x32x16_bf16 v[176:191], v[216:219], v[224:227], v[176:191]
v_mfma_f32_32x32x16_bf16 v[160:175], v[216:219], v[232:235], v[160:175]
v_mfma_f32_32x32x16_bf16 v[176:191], v[220:223], v[228:231], v[176:191]
v_mfma_f32_32x32x16_bf16 v[160:175], v[220:223], v[236:239], v[160:175]
ds_read_b128 v[216:219], v116 offset:2816
ds_read_b128 v[224:227], v117 offset:2880
ds_read_b128 v[232:235], v117 offset:832
ds_read_b128 v[220:223], v116 offset:2848
ds_read_b128 v[228:231], v117 offset:2912
ds_read_b128 v[236:239], v117 offset:864
s_waitcnt lgkmcnt(6)
v_mfma_f32_32x32x16_bf16 v[176:191], v[192:195], v[200:203], v[176:191]
v_mfma_f32_32x32x16_bf16 v[160:175], v[192:195], v[208:211], v[160:175]
v_mfma_f32_32x32x16_bf16 v[176:191], v[196:199], v[204:207], v[176:191]
v_mfma_f32_32x32x16_bf16 v[160:175], v[196:199], v[212:215], v[160:175]
ds_read_b128 v[192:195], v116 offset:2752
ds_read_b128 v[200:203], v117 offset:2816
ds_read_b128 v[208:211], v117 offset:768
ds_read_b128 v[196:199], v116 offset:2784
ds_read_b128 v[204:207], v117 offset:2848
ds_read_b128 v[212:215], v117 offset:800
s_waitcnt lgkmcnt(6)
v_mfma_f32_32x32x16_bf16 v[176:191], v[216:219], v[224:227], v[176:191]
v_mfma_f32_32x32x16_bf16 v[160:175], v[216:219], v[232:235], v[160:175]
v_mfma_f32_32x32x16_bf16 v[176:191], v[220:223], v[228:231], v[176:191]
v_mfma_f32_32x32x16_bf16 v[160:175], v[220:223], v[236:239], v[160:175]
ds_read_b128 v[216:219], v116 offset:2688
ds_read_b128 v[224:227], v117 offset:2752
ds_read_b128 v[232:235], v117 offset:704
ds_read_b128 v[220:223], v116 offset:2720
ds_read_b128 v[228:231], v117 offset:2784
ds_read_b128 v[236:239], v117 offset:736
s_waitcnt lgkmcnt(6)
v_mfma_f32_32x32x16_bf16 v[176:191], v[192:195], v[200:203], v[176:191]
v_mfma_f32_32x32x16_bf16 v[160:175], v[192:195], v[208:211], v[160:175]
v_mfma_f32_32x32x16_bf16 v[176:191], v[196:199], v[204:207], v[176:191]
v_mfma_f32_32x32x16_bf16 v[160:175], v[196:199], v[212:215], v[160:175]
ds_read_b128 v[192:195], v116 offset:2624
ds_read_b128 v[200:203], v117 offset:2688
ds_read_b128 v[208:211], v117 offset:640
ds_read_b128 v[196:199], v116 offset:2656
ds_read_b128 v[204:207], v117 offset:2720
ds_read_b128 v[212:215], v117 offset:672
s_waitcnt lgkmcnt(6)
v_mfma_f32_32x32x16_bf16 v[176:191], v[216:219], v[224:227], v[176:191]
v_mfma_f32_32x32x16_bf16 v[160:175], v[216:219], v[232:235], v[160:175]
v_mfma_f32_32x32x16_bf16 v[176:191], v[220:223], v[228:231], v[176:191]
v_mfma_f32_32x32x16_bf16 v[160:175], v[220:223], v[236:239], v[160:175]
ds_read_b128 v[216:219], v116 offset:2560
ds_read_b128 v[224:227], v117 offset:2624
ds_read_b128 v[232:235], v117 offset:576
ds_read_b128 v[220:223], v116 offset:2592
ds_read_b128 v[228:231], v117 offset:2656
ds_read_b128 v[236:239], v117 offset:608
s_waitcnt lgkmcnt(6)
v_mfma_f32_32x32x16_bf16 v[176:191], v[192:195], v[200:203], v[176:191]
v_mfma_f32_32x32x16_bf16 v[160:175], v[192:195], v[208:211], v[160:175]
v_mfma_f32_32x32x16_bf16 v[176:191], v[196:199], v[204:207], v[176:191]
v_mfma_f32_32x32x16_bf16 v[160:175], v[196:199], v[212:215], v[160:175]
ds_read_b128 v[192:195], v116 offset:2496
ds_read_b128 v[200:203], v117 offset:2560
ds_read_b128 v[208:211], v117 offset:512
ds_read_b128 v[196:199], v116 offset:2528
ds_read_b128 v[204:207], v117 offset:2592
ds_read_b128 v[212:215], v117 offset:544
s_waitcnt lgkmcnt(6)
v_mfma_f32_32x32x16_bf16 v[176:191], v[216:219], v[224:227], v[176:191]
v_mfma_f32_32x32x16_bf16 v[160:175], v[216:219], v[232:235], v[160:175]
v_mfma_f32_32x32x16_bf16 v[176:191], v[220:223], v[228:231], v[176:191]
v_mfma_f32_32x32x16_bf16 v[160:175], v[220:223], v[236:239], v[160:175]
ds_read_b128 v[216:219], v116 offset:2432
ds_read_b128 v[224:227], v117 offset:2496
ds_read_b128 v[232:235], v117 offset:448
ds_read_b128 v[220:223], v116 offset:2464
ds_read_b128 v[228:231], v117 offset:2528
ds_read_b128 v[236:239], v117 offset:480
s_waitcnt lgkmcnt(6)
v_mfma_f32_32x32x16_bf16 v[176:191], v[192:195], v[200:203], v[176:191]
v_mfma_f32_32x32x16_bf16 v[160:175], v[192:195], v[208:211], v[160:175]
v_mfma_f32_32x32x16_bf16 v[176:191], v[196:199], v[204:207], v[176:191]
v_mfma_f32_32x32x16_bf16 v[160:175], v[196:199], v[212:215], v[160:175]
ds_read_b128 v[192:195], v116 offset:2368
ds_read_b128 v[200:203], v117 offset:2432
ds_read_b128 v[208:211], v117 offset:384
ds_read_b128 v[196:199], v116 offset:2400
ds_read_b128 v[204:207], v117 offset:2464
ds_read_b128 v[212:215], v117 offset:416
s_waitcnt lgkmcnt(6)
v_mfma_f32_32x32x16_bf16 v[176:191], v[216:219], v[224:227], v[176:191]
v_mfma_f32_32x32x16_bf16 v[160:175], v[216:219], v[232:235], v[160:175]
v_mfma_f32_32x32x16_bf16 v[176:191], v[220:223], v[228:231], v[176:191]
v_mfma_f32_32x32x16_bf16 v[160:175], v[220:223], v[236:239], v[160:175]
ds_read_b128 v[216:219], v116 offset:2304
ds_read_b128 v[224:227], v117 offset:2368
ds_read_b128 v[232:235], v117 offset:320
ds_read_b128 v[220:223], v116 offset:2336
ds_read_b128 v[228:231], v117 offset:2400
ds_read_b128 v[236:239], v117 offset:352
s_waitcnt lgkmcnt(6)
v_mfma_f32_32x32x16_bf16 v[176:191], v[192:195], v[200:203], v[176:191]
v_mfma_f32_32x32x16_bf16 v[160:175], v[192:195], v[208:211], v[160:175]
v_mfma_f32_32x32x16_bf16 v[176:191], v[196:199], v[204:207], v[176:191]
v_mfma_f32_32x32x16_bf16 v[160:175], v[196:199], v[212:215], v[160:175]
ds_read_b128 v[192:195], v116 offset:2240
ds_read_b128 v[200:203], v117 offset:2304
ds_read_b128 v[208:211], v117 offset:256
ds_read_b128 v[196:199], v116 offset:2272
ds_read_b128 v[204:207], v117 offset:2336
ds_read_b128 v[212:215], v117 offset:288
s_waitcnt lgkmcnt(6)
v_mfma_f32_32x32x16_bf16 v[176:191], v[216:219], v[224:227], v[176:191]
v_mfma_f32_32x32x16_bf16 v[160:175], v[216:219], v[232:235], v[160:175]
v_mfma_f32_32x32x16_bf16 v[176:191], v[220:223], v[228:231], v[176:191]
v_mfma_f32_32x32x16_bf16 v[160:175], v[220:223], v[236:239], v[160:175]
ds_read_b128 v[216:219], v116 offset:2176
ds_read_b128 v[224:227], v117 offset:2240
ds_read_b128 v[232:235], v117 offset:192
ds_read_b128 v[220:223], v116 offset:2208
ds_read_b128 v[228:231], v117 offset:2272
ds_read_b128 v[236:239], v117 offset:224
s_waitcnt lgkmcnt(6)
v_mfma_f32_32x32x16_bf16 v[176:191], v[192:195], v[200:203], v[176:191]
v_mfma_f32_32x32x16_bf16 v[160:175], v[192:195], v[208:211], v[160:175]
v_mfma_f32_32x32x16_bf16 v[176:191], v[196:199], v[204:207], v[176:191]
v_mfma_f32_32x32x16_bf16 v[160:175], v[196:199], v[212:215], v[160:175]
ds_read_b128 v[192:195], v116 offset:2112
ds_read_b128 v[200:203], v117 offset:2176
ds_read_b128 v[208:211], v117 offset:128
ds_read_b128 v[196:199], v116 offset:2144
ds_read_b128 v[204:207], v117 offset:2208
ds_read_b128 v[212:215], v117 offset:160
s_waitcnt lgkmcnt(6)
v_mfma_f32_32x32x16_bf16 v[176:191], v[216:219], v[224:227], v[176:191]
v_mfma_f32_32x32x16_bf16 v[160:175], v[216:219], v[232:235], v[160:175]
v_mfma_f32_32x32x16_bf16 v[176:191], v[220:223], v[228:231], v[176:191]
v_mfma_f32_32x32x16_bf16 v[160:175], v[220:223], v[236:239], v[160:175]
ds_read_b128 v[216:219], v116 offset:2048
ds_read_b128 v[224:227], v117 offset:2112
ds_read_b128 v[232:235], v117 offset:64
ds_read_b128 v[220:223], v116 offset:2080
ds_read_b128 v[228:231], v117 offset:2144
ds_read_b128 v[236:239], v117 offset:96
s_waitcnt lgkmcnt(6)
v_mfma_f32_32x32x16_bf16 v[176:191], v[192:195], v[200:203], v[176:191]
v_mfma_f32_32x32x16_bf16 v[160:175], v[192:195], v[208:211], v[160:175]
v_mfma_f32_32x32x16_bf16 v[176:191], v[196:199], v[204:207], v[176:191]
v_mfma_f32_32x32x16_bf16 v[160:175], v[196:199], v[212:215], v[160:175]
ds_read_b128 v[192:195], v116 offset:1984
ds_read_b128 v[200:203], v117 offset:2048
ds_read_b128 v[196:199], v116 offset:2016
ds_read_b128 v[204:207], v117 offset:2080
s_waitcnt lgkmcnt(4)
v_mfma_f32_32x32x16_bf16 v[176:191], v[216:219], v[224:227], v[176:191]
v_mfma_f32_32x32x16_bf16 v[160:175], v[216:219], v[232:235], v[160:175]
v_mfma_f32_32x32x16_bf16 v[176:191], v[220:223], v[228:231], v[176:191]
v_mfma_f32_32x32x16_bf16 v[160:175], v[220:223], v[236:239], v[160:175]
ds_read_b128 v[216:219], v116 offset:1920
ds_read_b128 v[224:227], v117 offset:1984
ds_read_b128 v[220:223], v116 offset:1952
ds_read_b128 v[228:231], v117 offset:2016
s_waitcnt lgkmcnt(4)
v_mfma_f32_32x32x16_bf16 v[176:191], v[192:195], v[200:203], v[176:191]
v_mfma_f32_32x32x16_bf16 v[176:191], v[196:199], v[204:207], v[176:191]
ds_read_b128 v[192:195], v116 offset:1856
ds_read_b128 v[200:203], v117 offset:1920
ds_read_b128 v[196:199], v116 offset:1888
ds_read_b128 v[204:207], v117 offset:1952
s_waitcnt lgkmcnt(4)
v_mfma_f32_32x32x16_bf16 v[176:191], v[216:219], v[224:227], v[176:191]
v_mfma_f32_32x32x16_bf16 v[176:191], v[220:223], v[228:231], v[176:191]
ds_read_b128 v[216:219], v116 offset:1792
ds_read_b128 v[224:227], v117 offset:1856
ds_read_b128 v[220:223], v116 offset:1824
ds_read_b128 v[228:231], v117 offset:1888
s_waitcnt lgkmcnt(4)
v_mfma_f32_32x32x16_bf16 v[176:191], v[192:195], v[200:203], v[176:191]
v_mfma_f32_32x32x16_bf16 v[176:191], v[196:199], v[204:207], v[176:191]
ds_read_b128 v[192:195], v116 offset:1728
ds_read_b128 v[200:203], v117 offset:1792
ds_read_b128 v[196:199], v116 offset:1760
ds_read_b128 v[204:207], v117 offset:1824
s_waitcnt lgkmcnt(4)
v_mfma_f32_32x32x16_bf16 v[176:191], v[216:219], v[224:227], v[176:191]
v_mfma_f32_32x32x16_bf16 v[176:191], v[220:223], v[228:231], v[176:191]
ds_read_b128 v[216:219], v116 offset:1664
ds_read_b128 v[224:227], v117 offset:1728
ds_read_b128 v[220:223], v116 offset:1696
ds_read_b128 v[228:231], v117 offset:1760
s_waitcnt lgkmcnt(4)
v_mfma_f32_32x32x16_bf16 v[176:191], v[192:195], v[200:203], v[176:191]
v_mfma_f32_32x32x16_bf16 v[176:191], v[196:199], v[204:207], v[176:191]
ds_read_b128 v[192:195], v116 offset:1600
ds_read_b128 v[200:203], v117 offset:1664
ds_read_b128 v[196:199], v116 offset:1632
ds_read_b128 v[204:207], v117 offset:1696
s_waitcnt lgkmcnt(4)
v_mfma_f32_32x32x16_bf16 v[176:191], v[216:219], v[224:227], v[176:191]
v_mfma_f32_32x32x16_bf16 v[176:191], v[220:223], v[228:231], v[176:191]
ds_read_b128 v[216:219], v116 offset:1536
ds_read_b128 v[224:227], v117 offset:1600
ds_read_b128 v[220:223], v116 offset:1568
ds_read_b128 v[228:231], v117 offset:1632
s_waitcnt lgkmcnt(4)
v_mfma_f32_32x32x16_bf16 v[176:191], v[192:195], v[200:203], v[176:191]
v_mfma_f32_32x32x16_bf16 v[176:191], v[196:199], v[204:207], v[176:191]
ds_read_b128 v[192:195], v116 offset:1472
ds_read_b128 v[200:203], v117 offset:1536
ds_read_b128 v[196:199], v116 offset:1504
ds_read_b128 v[204:207], v117 offset:1568
s_waitcnt lgkmcnt(4)
v_mfma_f32_32x32x16_bf16 v[176:191], v[216:219], v[224:227], v[176:191]
v_mfma_f32_32x32x16_bf16 v[176:191], v[220:223], v[228:231], v[176:191]
ds_read_b128 v[216:219], v116 offset:1408
ds_read_b128 v[224:227], v117 offset:1472
ds_read_b128 v[220:223], v116 offset:1440
ds_read_b128 v[228:231], v117 offset:1504
s_waitcnt lgkmcnt(4)
v_mfma_f32_32x32x16_bf16 v[176:191], v[192:195], v[200:203], v[176:191]
v_mfma_f32_32x32x16_bf16 v[176:191], v[196:199], v[204:207], v[176:191]
ds_read_b128 v[192:195], v116 offset:1344
ds_read_b128 v[200:203], v117 offset:1408
ds_read_b128 v[196:199], v116 offset:1376
ds_read_b128 v[204:207], v117 offset:1440
s_waitcnt lgkmcnt(4)
v_mfma_f32_32x32x16_bf16 v[176:191], v[216:219], v[224:227], v[176:191]
v_mfma_f32_32x32x16_bf16 v[176:191], v[220:223], v[228:231], v[176:191]
ds_read_b128 v[216:219], v116 offset:1280
ds_read_b128 v[224:227], v117 offset:1344
ds_read_b128 v[220:223], v116 offset:1312
ds_read_b128 v[228:231], v117 offset:1376
s_waitcnt lgkmcnt(4)
v_mfma_f32_32x32x16_bf16 v[176:191], v[192:195], v[200:203], v[176:191]
v_mfma_f32_32x32x16_bf16 v[176:191], v[196:199], v[204:207], v[176:191]
ds_read_b128 v[192:195], v116 offset:1216
ds_read_b128 v[200:203], v117 offset:1280
ds_read_b128 v[196:199], v116 offset:1248
ds_read_b128 v[204:207], v117 offset:1312
s_waitcnt lgkmcnt(4)
v_mfma_f32_32x32x16_bf16 v[176:191], v[216:219], v[224:227], v[176:191]
v_mfma_f32_32x32x16_bf16 v[176:191], v[220:223], v[228:231], v[176:191]
ds_read_b128 v[216:219], v116 offset:1152
ds_read_b128 v[224:227], v117 offset:1216
ds_read_b128 v[220:223], v116 offset:1184
ds_read_b128 v[228:231], v117 offset:1248
s_waitcnt lgkmcnt(4)
v_mfma_f32_32x32x16_bf16 v[176:191], v[192:195], v[200:203], v[176:191]
v_mfma_f32_32x32x16_bf16 v[176:191], v[196:199], v[204:207], v[176:191]
ds_read_b128 v[192:195], v116 offset:1088
ds_read_b128 v[200:203], v117 offset:1152
ds_read_b128 v[196:199], v116 offset:1120
ds_read_b128 v[204:207], v117 offset:1184
s_waitcnt lgkmcnt(4)
v_mfma_f32_32x32x16_bf16 v[176:191], v[216:219], v[224:227], v[176:191]
v_mfma_f32_32x32x16_bf16 v[176:191], v[220:223], v[228:231], v[176:191]
ds_read_b128 v[216:219], v116 offset:1024
ds_read_b128 v[224:227], v117 offset:1088
ds_read_b128 v[220:223], v116 offset:1056
ds_read_b128 v[228:231], v117 offset:1120
s_waitcnt lgkmcnt(4)
v_mfma_f32_32x32x16_bf16 v[176:191], v[192:195], v[200:203], v[176:191]
v_mfma_f32_32x32x16_bf16 v[176:191], v[196:199], v[204:207], v[176:191]
ds_read_b128 v[192:195], v116 offset:960
ds_read_b128 v[200:203], v117 offset:1024
ds_read_b128 v[196:199], v116 offset:992
ds_read_b128 v[204:207], v117 offset:1056
s_waitcnt lgkmcnt(4)
v_mfma_f32_32x32x16_bf16 v[176:191], v[216:219], v[224:227], v[176:191]
v_mfma_f32_32x32x16_bf16 v[176:191], v[220:223], v[228:231], v[176:191]
ds_read_b128 v[216:219], v116 offset:896
ds_read_b128 v[224:227], v117 offset:960
ds_read_b128 v[220:223], v116 offset:928
ds_read_b128 v[228:231], v117 offset:992
s_waitcnt lgkmcnt(4)
v_mfma_f32_32x32x16_bf16 v[176:191], v[192:195], v[200:203], v[176:191]
v_mfma_f32_32x32x16_bf16 v[176:191], v[196:199], v[204:207], v[176:191]
ds_read_b128 v[192:195], v116 offset:832
ds_read_b128 v[200:203], v117 offset:896
ds_read_b128 v[196:199], v116 offset:864
ds_read_b128 v[204:207], v117 offset:928
s_waitcnt lgkmcnt(4)
v_mfma_f32_32x32x16_bf16 v[176:191], v[216:219], v[224:227], v[176:191]
v_mfma_f32_32x32x16_bf16 v[176:191], v[220:223], v[228:231], v[176:191]
ds_read_b128 v[216:219], v116 offset:768
ds_read_b128 v[224:227], v117 offset:832
ds_read_b128 v[220:223], v116 offset:800
ds_read_b128 v[228:231], v117 offset:864
s_waitcnt lgkmcnt(4)
v_mfma_f32_32x32x16_bf16 v[176:191], v[192:195], v[200:203], v[176:191]
v_mfma_f32_32x32x16_bf16 v[176:191], v[196:199], v[204:207], v[176:191]
ds_read_b128 v[192:195], v116 offset:704
ds_read_b128 v[200:203], v117 offset:768
ds_read_b128 v[196:199], v116 offset:736
ds_read_b128 v[204:207], v117 offset:800
s_waitcnt lgkmcnt(4)
v_mfma_f32_32x32x16_bf16 v[176:191], v[216:219], v[224:227], v[176:191]
v_mfma_f32_32x32x16_bf16 v[176:191], v[220:223], v[228:231], v[176:191]
ds_read_b128 v[216:219], v116 offset:640
ds_read_b128 v[224:227], v117 offset:704
ds_read_b128 v[220:223], v116 offset:672
ds_read_b128 v[228:231], v117 offset:736
s_waitcnt lgkmcnt(4)
v_mfma_f32_32x32x16_bf16 v[176:191], v[192:195], v[200:203], v[176:191]
v_mfma_f32_32x32x16_bf16 v[176:191], v[196:199], v[204:207], v[176:191]
ds_read_b128 v[192:195], v116 offset:576
ds_read_b128 v[200:203], v117 offset:640
ds_read_b128 v[196:199], v116 offset:608
ds_read_b128 v[204:207], v117 offset:672
s_waitcnt lgkmcnt(4)
v_mfma_f32_32x32x16_bf16 v[176:191], v[216:219], v[224:227], v[176:191]
v_mfma_f32_32x32x16_bf16 v[176:191], v[220:223], v[228:231], v[176:191]
ds_read_b128 v[216:219], v116 offset:512
ds_read_b128 v[224:227], v117 offset:576
ds_read_b128 v[220:223], v116 offset:544
ds_read_b128 v[228:231], v117 offset:608
s_waitcnt lgkmcnt(4)
v_mfma_f32_32x32x16_bf16 v[176:191], v[192:195], v[200:203], v[176:191]
v_mfma_f32_32x32x16_bf16 v[176:191], v[196:199], v[204:207], v[176:191]
ds_read_b128 v[192:195], v116 offset:448
ds_read_b128 v[200:203], v117 offset:512
ds_read_b128 v[196:199], v116 offset:480
ds_read_b128 v[204:207], v117 offset:544
s_waitcnt lgkmcnt(4)
v_mfma_f32_32x32x16_bf16 v[176:191], v[216:219], v[224:227], v[176:191]
v_mfma_f32_32x32x16_bf16 v[176:191], v[220:223], v[228:231], v[176:191]
ds_read_b128 v[216:219], v116 offset:384
ds_read_b128 v[224:227], v117 offset:448
ds_read_b128 v[220:223], v116 offset:416
ds_read_b128 v[228:231], v117 offset:480
s_waitcnt lgkmcnt(4)
v_mfma_f32_32x32x16_bf16 v[176:191], v[192:195], v[200:203], v[176:191]
v_mfma_f32_32x32x16_bf16 v[176:191], v[196:199], v[204:207], v[176:191]
ds_read_b128 v[192:195], v116 offset:320
ds_read_b128 v[200:203], v117 offset:384
ds_read_b128 v[196:199], v116 offset:352
ds_read_b128 v[204:207], v117 offset:416
s_waitcnt lgkmcnt(4)
v_mfma_f32_32x32x16_bf16 v[176:191], v[216:219], v[224:227], v[176:191]
v_mfma_f32_32x32x16_bf16 v[176:191], v[220:223], v[228:231], v[176:191]
ds_read_b128 v[216:219], v116 offset:256
ds_read_b128 v[224:227], v117 offset:320
ds_read_b128 v[220:223], v116 offset:288
ds_read_b128 v[228:231], v117 offset:352
s_waitcnt lgkmcnt(4)
v_mfma_f32_32x32x16_bf16 v[176:191], v[192:195], v[200:203], v[176:191]
v_mfma_f32_32x32x16_bf16 v[176:191], v[196:199], v[204:207], v[176:191]
ds_read_b128 v[192:195], v116 offset:192
ds_read_b128 v[200:203], v117 offset:256
ds_read_b128 v[196:199], v116 offset:224
ds_read_b128 v[204:207], v117 offset:288
s_waitcnt lgkmcnt(4)
v_mfma_f32_32x32x16_bf16 v[176:191], v[216:219], v[224:227], v[176:191]
v_mfma_f32_32x32x16_bf16 v[176:191], v[220:223], v[228:231], v[176:191]
ds_read_b128 v[216:219], v116 offset:128
ds_read_b128 v[224:227], v117 offset:192
ds_read_b128 v[220:223], v116 offset:160
ds_read_b128 v[228:231], v117 offset:224
s_waitcnt lgkmcnt(4)
v_mfma_f32_32x32x16_bf16 v[176:191], v[192:195], v[200:203], v[176:191]
v_mfma_f32_32x32x16_bf16 v[176:191], v[196:199], v[204:207], v[176:191]
ds_read_b128 v[192:195], v116 offset:64
ds_read_b128 v[200:203], v117 offset:128
ds_read_b128 v[196:199], v116 offset:96
ds_read_b128 v[204:207], v117 offset:160
s_waitcnt lgkmcnt(4)
v_mfma_f32_32x32x16_bf16 v[176:191], v[216:219], v[224:227], v[176:191]
v_mfma_f32_32x32x16_bf16 v[176:191], v[220:223], v[228:231], v[176:191]
ds_read_b128 v[216:219], v116 offset:0
ds_read_b128 v[224:227], v117 offset:64
ds_read_b128 v[220:223], v116 offset:32
ds_read_b128 v[228:231], v117 offset:96
s_waitcnt lgkmcnt(4)
v_mfma_f32_32x32x16_bf16 v[176:191], v[192:195], v[200:203], v[176:191]
v_mfma_f32_32x32x16_bf16 v[176:191], v[196:199], v[204:207], v[176:191]
s_waitcnt lgkmcnt(0)
v_mfma_f32_32x32x16_bf16 v[176:191], v[216:219], v[224:227], v[176:191]
v_mfma_f32_32x32x16_bf16 v[176:191], v[220:223], v[228:231], v[176:191]
s_nop 7
s_nop 7
v_lshlrev_b32 v7, 7, v5
v_lshlrev_b32 v8, 4, v6
v_add3_u32 v7, v7, v8, s18
ds_write_b128 v7, v[160:163] offset:0
ds_write_b128 v7, v[164:167] offset:32
ds_write_b128 v7, v[168:171] offset:64
ds_write_b128 v7, v[172:175] offset:96
ds_write_b128 v7, v[176:179] offset:4096
ds_write_b128 v7, v[180:183] offset:4128
ds_write_b128 v7, v[184:187] offset:4160
ds_write_b128 v7, v[188:191] offset:4192
s_waitcnt lgkmcnt(0)
s_barrier
v_lshlrev_b32 v6, 5, v0
v_add_u32 v7, 0, v6
ds_read_b128 v[128:131], v7
ds_read_b128 v[132:135], v7 offset:16
v_add_u32 v7, 39680, v6
ds_read_b128 v[136:139], v7
ds_read_b128 v[140:143], v7 offset:16
v_add_u32 v7, 79360, v6
ds_read_b128 v[144:147], v7
ds_read_b128 v[148:151], v7 offset:16
v_add_u32 v7, 119040, v6
ds_read_b128 v[152:155], v7
ds_read_b128 v[156:159], v7 offset:16
s_waitcnt lgkmcnt(0)
v_cvt_pk_bf16_f32 v9, v128, v128
v_lshlrev_b32 v128, 16, v9
v_add_f32 v128, v128, v64
v_cvt_pk_bf16_f32 v9, v128, v128
v_lshlrev_b32 v128, 16, v9
v_lshlrev_b32 v7, 16, v48
v_mul_f32 v128, v128, v7
v_cvt_pk_bf16_f32 v9, v136, v136
v_lshlrev_b32 v136, 16, v9
v_add_f32 v136, v136, v65
v_cvt_pk_bf16_f32 v9, v136, v136
v_lshlrev_b32 v136, 16, v9
v_and_b32 v7, 0xffff0000, v48
v_mul_f32 v136, v136, v7
v_cvt_pk_bf16_f32 v9, v144, v144
v_lshlrev_b32 v144, 16, v9
v_add_f32 v144, v144, v66
v_cvt_pk_bf16_f32 v9, v144, v144
v_lshlrev_b32 v144, 16, v9
v_lshlrev_b32 v7, 16, v49
v_mul_f32 v144, v144, v7
v_cvt_pk_bf16_f32 v9, v152, v152
v_lshlrev_b32 v152, 16, v9
v_add_f32 v152, v152, v67
v_cvt_pk_bf16_f32 v9, v152, v152
v_lshlrev_b32 v152, 16, v9
v_and_b32 v7, 0xffff0000, v49
v_mul_f32 v152, v152, v7
v_cvt_pk_bf16_f32 v10, v128, v136
v_cvt_pk_bf16_f32 v11, v144, v152
v_mul_u32_u24 v7, 20480, v0
s_lshl_b32 s3, s2, 3
v_add_u32 v7, s3, v7
s_mov_b32 s18, 0
buffer_store_dwordx2 v[10:11], v7, s[32:35], s18 offen
s_nop 1
v_cvt_pk_bf16_f32 v9, v129, v129
v_lshlrev_b32 v129, 16, v9
v_add_f32 v129, v129, v68
v_cvt_pk_bf16_f32 v9, v129, v129
v_lshlrev_b32 v129, 16, v9
v_lshlrev_b32 v7, 16, v50
v_mul_f32 v129, v129, v7
v_cvt_pk_bf16_f32 v9, v137, v137
v_lshlrev_b32 v137, 16, v9
v_add_f32 v137, v137, v69
v_cvt_pk_bf16_f32 v9, v137, v137
v_lshlrev_b32 v137, 16, v9
v_and_b32 v7, 0xffff0000, v50
v_mul_f32 v137, v137, v7
v_cvt_pk_bf16_f32 v9, v145, v145
v_lshlrev_b32 v145, 16, v9
v_add_f32 v145, v145, v70
v_cvt_pk_bf16_f32 v9, v145, v145
v_lshlrev_b32 v145, 16, v9
v_lshlrev_b32 v7, 16, v51
v_mul_f32 v145, v145, v7
v_cvt_pk_bf16_f32 v9, v153, v153
v_lshlrev_b32 v153, 16, v9
v_add_f32 v153, v153, v71
v_cvt_pk_bf16_f32 v9, v153, v153
v_lshlrev_b32 v153, 16, v9
v_and_b32 v7, 0xffff0000, v51
v_mul_f32 v153, v153, v7
v_cvt_pk_bf16_f32 v10, v129, v137
v_cvt_pk_bf16_f32 v11, v145, v153
v_mul_u32_u24 v7, 20480, v0
s_lshl_b32 s3, s2, 3
v_add_u32 v7, s3, v7
s_mov_b32 s18, 2560
buffer_store_dwordx2 v[10:11], v7, s[32:35], s18 offen
s_nop 1
v_cvt_pk_bf16_f32 v9, v130, v130
v_lshlrev_b32 v130, 16, v9
v_add_f32 v130, v130, v72
v_cvt_pk_bf16_f32 v9, v130, v130
v_lshlrev_b32 v130, 16, v9
v_lshlrev_b32 v7, 16, v52
v_mul_f32 v130, v130, v7
v_cvt_pk_bf16_f32 v9, v138, v138
v_lshlrev_b32 v138, 16, v9
v_add_f32 v138, v138, v73
v_cvt_pk_bf16_f32 v9, v138, v138
v_lshlrev_b32 v138, 16, v9
v_and_b32 v7, 0xffff0000, v52
v_mul_f32 v138, v138, v7
v_cvt_pk_bf16_f32 v9, v146, v146
v_lshlrev_b32 v146, 16, v9
v_add_f32 v146, v146, v74
v_cvt_pk_bf16_f32 v9, v146, v146
v_lshlrev_b32 v146, 16, v9
v_lshlrev_b32 v7, 16, v53
v_mul_f32 v146, v146, v7
v_cvt_pk_bf16_f32 v9, v154, v154
v_lshlrev_b32 v154, 16, v9
v_add_f32 v154, v154, v75
v_cvt_pk_bf16_f32 v9, v154, v154
v_lshlrev_b32 v154, 16, v9
v_and_b32 v7, 0xffff0000, v53
v_mul_f32 v154, v154, v7
v_cvt_pk_bf16_f32 v10, v130, v138
v_cvt_pk_bf16_f32 v11, v146, v154
v_mul_u32_u24 v7, 20480, v0
s_lshl_b32 s3, s2, 3
v_add_u32 v7, s3, v7
s_mov_b32 s18, 5120
buffer_store_dwordx2 v[10:11], v7, s[32:35], s18 offen
s_nop 1
v_cvt_pk_bf16_f32 v9, v131, v131
v_lshlrev_b32 v131, 16, v9
v_add_f32 v131, v131, v76
v_cvt_pk_bf16_f32 v9, v131, v131
v_lshlrev_b32 v131, 16, v9
v_lshlrev_b32 v7, 16, v54
v_mul_f32 v131, v131, v7
v_cvt_pk_bf16_f32 v9, v139, v139
v_lshlrev_b32 v139, 16, v9
v_add_f32 v139, v139, v77
v_cvt_pk_bf16_f32 v9, v139, v139
v_lshlrev_b32 v139, 16, v9
v_and_b32 v7, 0xffff0000, v54
v_mul_f32 v139, v139, v7
v_cvt_pk_bf16_f32 v9, v147, v147
v_lshlrev_b32 v147, 16, v9
v_add_f32 v147, v147, v78
v_cvt_pk_bf16_f32 v9, v147, v147
v_lshlrev_b32 v147, 16, v9
v_lshlrev_b32 v7, 16, v55
v_mul_f32 v147, v147, v7
v_cvt_pk_bf16_f32 v9, v155, v155
v_lshlrev_b32 v155, 16, v9
v_add_f32 v155, v155, v79
v_cvt_pk_bf16_f32 v9, v155, v155
v_lshlrev_b32 v155, 16, v9
v_and_b32 v7, 0xffff0000, v55
v_mul_f32 v155, v155, v7
v_cvt_pk_bf16_f32 v10, v131, v139
v_cvt_pk_bf16_f32 v11, v147, v155
v_mul_u32_u24 v7, 20480, v0
s_lshl_b32 s3, s2, 3
v_add_u32 v7, s3, v7
s_mov_b32 s18, 7680
buffer_store_dwordx2 v[10:11], v7, s[32:35], s18 offen
s_nop 1
v_cvt_pk_bf16_f32 v9, v132, v132
v_lshlrev_b32 v132, 16, v9
v_add_f32 v132, v132, v80
v_cvt_pk_bf16_f32 v9, v132, v132
v_lshlrev_b32 v132, 16, v9
v_lshlrev_b32 v7, 16, v56
v_mul_f32 v132, v132, v7
v_cvt_pk_bf16_f32 v9, v140, v140
v_lshlrev_b32 v140, 16, v9
v_add_f32 v140, v140, v81
v_cvt_pk_bf16_f32 v9, v140, v140
v_lshlrev_b32 v140, 16, v9
v_and_b32 v7, 0xffff0000, v56
v_mul_f32 v140, v140, v7
v_cvt_pk_bf16_f32 v9, v148, v148
v_lshlrev_b32 v148, 16, v9
v_add_f32 v148, v148, v82
v_cvt_pk_bf16_f32 v9, v148, v148
v_lshlrev_b32 v148, 16, v9
v_lshlrev_b32 v7, 16, v57
v_mul_f32 v148, v148, v7
v_cvt_pk_bf16_f32 v9, v156, v156
v_lshlrev_b32 v156, 16, v9
v_add_f32 v156, v156, v83
v_cvt_pk_bf16_f32 v9, v156, v156
v_lshlrev_b32 v156, 16, v9
v_and_b32 v7, 0xffff0000, v57
v_mul_f32 v156, v156, v7
v_cvt_pk_bf16_f32 v10, v132, v140
v_cvt_pk_bf16_f32 v11, v148, v156
v_mul_u32_u24 v7, 20480, v0
s_lshl_b32 s3, s2, 3
v_add_u32 v7, s3, v7
s_mov_b32 s18, 10240
buffer_store_dwordx2 v[10:11], v7, s[32:35], s18 offen
s_nop 1
v_cvt_pk_bf16_f32 v9, v133, v133
v_lshlrev_b32 v133, 16, v9
v_add_f32 v133, v133, v84
v_cvt_pk_bf16_f32 v9, v133, v133
v_lshlrev_b32 v133, 16, v9
v_lshlrev_b32 v7, 16, v58
v_mul_f32 v133, v133, v7
v_cvt_pk_bf16_f32 v9, v141, v141
v_lshlrev_b32 v141, 16, v9
v_add_f32 v141, v141, v85
v_cvt_pk_bf16_f32 v9, v141, v141
v_lshlrev_b32 v141, 16, v9
v_and_b32 v7, 0xffff0000, v58
v_mul_f32 v141, v141, v7
v_cvt_pk_bf16_f32 v9, v149, v149
v_lshlrev_b32 v149, 16, v9
v_add_f32 v149, v149, v86
v_cvt_pk_bf16_f32 v9, v149, v149
v_lshlrev_b32 v149, 16, v9
v_lshlrev_b32 v7, 16, v59
v_mul_f32 v149, v149, v7
v_cvt_pk_bf16_f32 v9, v157, v157
v_lshlrev_b32 v157, 16, v9
v_add_f32 v157, v157, v87
v_cvt_pk_bf16_f32 v9, v157, v157
v_lshlrev_b32 v157, 16, v9
v_and_b32 v7, 0xffff0000, v59
v_mul_f32 v157, v157, v7
v_cvt_pk_bf16_f32 v10, v133, v141
v_cvt_pk_bf16_f32 v11, v149, v157
v_mul_u32_u24 v7, 20480, v0
s_lshl_b32 s3, s2, 3
v_add_u32 v7, s3, v7
s_mov_b32 s18, 12800
buffer_store_dwordx2 v[10:11], v7, s[32:35], s18 offen
s_nop 1
v_cvt_pk_bf16_f32 v9, v134, v134
v_lshlrev_b32 v134, 16, v9
v_add_f32 v134, v134, v88
v_cvt_pk_bf16_f32 v9, v134, v134
v_lshlrev_b32 v134, 16, v9
v_lshlrev_b32 v7, 16, v60
v_mul_f32 v134, v134, v7
v_cvt_pk_bf16_f32 v9, v142, v142
v_lshlrev_b32 v142, 16, v9
v_add_f32 v142, v142, v89
v_cvt_pk_bf16_f32 v9, v142, v142
v_lshlrev_b32 v142, 16, v9
v_and_b32 v7, 0xffff0000, v60
v_mul_f32 v142, v142, v7
v_cvt_pk_bf16_f32 v9, v150, v150
v_lshlrev_b32 v150, 16, v9
v_add_f32 v150, v150, v90
v_cvt_pk_bf16_f32 v9, v150, v150
v_lshlrev_b32 v150, 16, v9
v_lshlrev_b32 v7, 16, v61
v_mul_f32 v150, v150, v7
v_cvt_pk_bf16_f32 v9, v158, v158
v_lshlrev_b32 v158, 16, v9
v_add_f32 v158, v158, v91
v_cvt_pk_bf16_f32 v9, v158, v158
v_lshlrev_b32 v158, 16, v9
v_and_b32 v7, 0xffff0000, v61
v_mul_f32 v158, v158, v7
v_cvt_pk_bf16_f32 v10, v134, v142
v_cvt_pk_bf16_f32 v11, v150, v158
v_mul_u32_u24 v7, 20480, v0
s_lshl_b32 s3, s2, 3
v_add_u32 v7, s3, v7
s_mov_b32 s18, 15360
buffer_store_dwordx2 v[10:11], v7, s[32:35], s18 offen
s_nop 1
v_cvt_pk_bf16_f32 v9, v135, v135
v_lshlrev_b32 v135, 16, v9
v_add_f32 v135, v135, v92
v_cvt_pk_bf16_f32 v9, v135, v135
v_lshlrev_b32 v135, 16, v9
v_lshlrev_b32 v7, 16, v62
v_mul_f32 v135, v135, v7
v_cvt_pk_bf16_f32 v9, v143, v143
v_lshlrev_b32 v143, 16, v9
v_add_f32 v143, v143, v93
v_cvt_pk_bf16_f32 v9, v143, v143
v_lshlrev_b32 v143, 16, v9
v_and_b32 v7, 0xffff0000, v62
v_mul_f32 v143, v143, v7
v_cvt_pk_bf16_f32 v9, v151, v151
v_lshlrev_b32 v151, 16, v9
v_add_f32 v151, v151, v94
v_cvt_pk_bf16_f32 v9, v151, v151
v_lshlrev_b32 v151, 16, v9
v_lshlrev_b32 v7, 16, v63
v_mul_f32 v151, v151, v7
v_cvt_pk_bf16_f32 v9, v159, v159
v_lshlrev_b32 v159, 16, v9
v_add_f32 v159, v159, v95
v_cvt_pk_bf16_f32 v9, v159, v159
v_lshlrev_b32 v159, 16, v9
v_and_b32 v7, 0xffff0000, v63
v_mul_f32 v159, v159, v7
v_cvt_pk_bf16_f32 v10, v135, v143
v_cvt_pk_bf16_f32 v11, v151, v159
v_mul_u32_u24 v7, 20480, v0
s_lshl_b32 s3, s2, 3
v_add_u32 v7, s3, v7
s_mov_b32 s18, 17920
buffer_store_dwordx2 v[10:11], v7, s[32:35], s18 offen
s_nop 1
pa_kernel_done:
s_endpgm
.section .rodata,"a"
.p2align 6
.amdhsa_kernel g1_kernel
  .amdhsa_next_free_vgpr 256
  .amdhsa_next_free_sgpr 100
  .amdhsa_accum_offset 256
  .amdhsa_group_segment_fixed_size 0
  .amdhsa_kernarg_size 112
  .amdhsa_user_sgpr_count 2
  .amdhsa_user_sgpr_kernarg_segment_ptr 1
  .amdhsa_system_sgpr_workgroup_id_x 1
.end_amdhsa_kernel
.p2align 6
.amdhsa_kernel g2_kernel
  .amdhsa_next_free_vgpr 256
  .amdhsa_next_free_sgpr 100
  .amdhsa_accum_offset 256
  .amdhsa_group_segment_fixed_size 0
  .amdhsa_kernarg_size 112
  .amdhsa_user_sgpr_count 2
  .amdhsa_user_sgpr_kernarg_segment_ptr 1
  .amdhsa_system_sgpr_workgroup_id_x 1
.end_amdhsa_kernel
.p2align 6
.amdhsa_kernel cb_kernel
  .amdhsa_next_free_vgpr 64
  .amdhsa_next_free_sgpr 100
  .amdhsa_accum_offset 64
  .amdhsa_group_segment_fixed_size 0
  .amdhsa_kernarg_size 112
  .amdhsa_user_sgpr_count 2
  .amdhsa_user_sgpr_kernarg_segment_ptr 1
  .amdhsa_system_sgpr_workgroup_id_x 1
.end_amdhsa_kernel
.p2align 6
.amdhsa_kernel pa_kernel
  .amdhsa_next_free_vgpr 256
  .amdhsa_next_free_sgpr 100
  .amdhsa_accum_offset 256
  .amdhsa_group_segment_fixed_size 0
  .amdhsa_kernarg_size 112
  .amdhsa_user_sgpr_count 2
  .amdhsa_user_sgpr_kernarg_segment_ptr 1
  .amdhsa_system_sgpr_workgroup_id_x 1
.end_amdhsa_kernel
```
